```python
import torch

def _softmax(x, axis=-1):
    return torch.softmax(x, dim=axis)
def _gelu(x):
    return torch.nn.functional.gelu(x, approximate="tanh")
def _silu(x):
    return torch.nn.functional.silu(x)
def _sigmoid(x):
    return torch.sigmoid(x)
def _layernorm(x, axis=-1, eps=1e-5):
    m = x.mean(dim=axis, keepdim=True)
    v = x.var(dim=axis, keepdim=True, unbiased=False)
    return (x - m) / torch.sqrt(v + eps)
def _scatter_add(tgt, idx, src, axis=0):
    return tgt.clone().index_add_(axis, idx, src)
def _segment_sum(src, seg, n):
    out = torch.zeros((n,) + src.shape[1:], dtype=src.dtype)
    return out.index_add_(0, seg, src)
def _pad(x, pw):
    flat = tuple(v for pair in reversed(pw) for v in pair)
    return torch.nn.functional.pad(x, flat)

kernel_name = 'sequential_preLN__compressed_kv_cla__dense_activation_silu__decode'

def setup_inputs():

    _w = (lambda a: (lambda t: t.to(torch.bfloat16) if t.is_floating_point() else t)(torch.as_tensor(a)))
    def _A_setup():
        B, H, Sq, Sk, D, M = 2, 32, 1, 4096, 128, 640
        Dc = 4 * D
        return {
            "x": _w((lambda *s: torch.randn(*s, dtype=torch.bfloat16) * 0.05)(B, Sq, M)),
            "c_kv": _w((lambda *s: torch.randn(*s, dtype=torch.bfloat16) * 0.8)(B, Sk, Dc)),
            "w_q": _w((lambda *s: torch.randn(*s, dtype=torch.bfloat16) * 3.2)(M, H, D) * (M ** -0.5)),
            "w_uk": _w((lambda *s: torch.randn(*s, dtype=torch.bfloat16) * 3.2)(Dc, H, D) * (Dc ** -0.5)),
            "w_uv": _w((lambda *s: torch.randn(*s, dtype=torch.bfloat16) * 0.8)(Dc, H, D) * (Dc ** -0.5)),
            "w_o": _w((lambda *s: torch.randn(*s, dtype=torch.bfloat16) * 0.8)(H, D, M) * ((H * D) ** -0.5)),
        }
    _A_in = _A_setup()

    def _B_setup():
        B, S, D, F = 2, 1, 640, 1728
        return {
            "x": _w((lambda *s: torch.randn(*s, dtype=torch.bfloat16) * 0.05)(B, S, D)),
            "w1": _w((lambda *s: torch.randn(*s, dtype=torch.bfloat16) * 3.2)(D, F) * (D ** -0.5)),
            "w2": _w((lambda *s: torch.randn(*s, dtype=torch.bfloat16) * 0.4)(F, D) * (F ** -0.5)),
        }
    _B_in = _B_setup()

    return {
        "A_x": _A_in["x"],
        "A_c_kv": _A_in["c_kv"],
        "A_w_q": _A_in["w_q"],
        "A_w_uk": _A_in["w_uk"],
        "A_w_uv": _A_in["w_uv"],
        "A_w_o": _A_in["w_o"],
        "B_x": _B_in["x"],
        "B_w1": _B_in["w1"],
        "B_w2": _B_in["w2"],
    }

def reference(A_x, A_c_kv, A_w_q, A_w_uk, A_w_uv, A_w_o, B_x, B_w1, B_w2):
    def _A_ref(x, c_kv, w_q, w_uk, w_uv, w_o):
        B, Sq, M = x.shape[0], x.shape[1], x.shape[2]
        Sk = c_kv.shape[1]
        H, D = w_q.shape[1], w_q.shape[2]
        q = torch.einsum("bqm,mhd->bhqd", x, w_q)
        k = torch.einsum("bkc,chd->bhkd", c_kv, w_uk)
        v = torch.einsum("bkc,chd->bhkd", c_kv, w_uv)
        scores = torch.einsum("bhqd,bhkd->bhqk", q, k) * (D ** -0.5)
        off = Sk - Sq
        qi = torch.arange(Sq)[:, None]
        kj = torch.arange(Sk)[None, :]
        cmask = kj <= (qi + off)
        scores = torch.where(cmask[None, None], scores, -1e9)
        p = _softmax(scores, axis=-1)
        ctx = torch.einsum("bhqk,bhkd->bhqd", p, v)
        return torch.einsum("bhqd,hdm->bqm", ctx, w_o)

    def _B_ref(x, w1, w2):
        h = torch.einsum("bsd,df->bsf", x, w1)
        h = _silu(h)
        out = torch.einsum("bsf,fd->bsd", h, w2)
        return out

    x = A_x
    h = x + _A_ref(_layernorm(x, axis=-1), A_c_kv, A_w_q, A_w_uk, A_w_uv, A_w_o)
    h2 = h + _B_ref(_layernorm(h, axis=-1), B_w1, B_w2)
    return h2
```

```asm
; @launch grid=(256,1,1) block=(256,1,1) lds=163840
.amdgcn_target "amdgcn-amd-amdhsa--gfx950"
.text
.globl sequential_preLN__compressed_kv_cla__dense_activation_silu__decode_kernel
.p2align 8
.type sequential_preLN__compressed_kv_cla__dense_activation_silu__decode_kernel,@function
sequential_preLN__compressed_kv_cla__dense_activation_silu__decode_kernel:
    s_cmp_ge_u32 s2, 256
    s_cbranch_scc1 L_end
    s_load_dwordx16 s[4:19], s[0:1], 0
    s_load_dwordx8 s[20:27], s[0:1], 64
    s_getpc_b64 s[62:63]
L_pc:
    s_lshr_b32 s30, s2, 3
    s_lshl_b32 s30, s30, 9
    v_lshl_add_u32 v4, v0, 7, s30
    v_min_u32 v4, L_end-L_pc, v4
    v_cmp_gt_u32 vcc, 4, v0
    s_and_saveexec_b64 s[88:89], vcc
    s_cbranch_execz L_nopf
    global_load_dword v255, v4, s[62:63]
L_nopf:
    s_mov_b64 exec, -1
    v_lshrrev_b32 v1, 6, v0
    v_and_b32 v0, 63, v0
    v_readfirstlane_b32 s45, v1
    v_and_b32 v1, 15, v0
    v_lshrrev_b32 v2, 4, v0
    v_lshlrev_b32 v3, 4, v0
    v_and_b32 v9, 3, v0
    v_bfe_u32 v10, v0, 2, 2
    s_and_b32 s46, s2, 7
    s_lshr_b32 s47, s2, 4
    s_mov_b32 s48, 0x00010001
    s_mov_b32 s3, 0x07060302
    s_mov_b32 s30, 3670016
    s_mov_b32 s31, 0x20000
    s_mov_b32 s35, 0x20000
    s_mov_b32 s39, 0x20000
    s_mov_b32 s43, 0x20000
    s_lshr_b32 s51, s47, 2
    s_lshl_b32 s52, s46, 2
    s_and_b32 s53, s47, 3
    s_bitcmp1_b32 s2, 3
    s_cbranch_scc1 L_Y
    v_lshlrev_b32 v4, 2, v2
    v_xor_b32 v4, v4, v1
    v_lshlrev_b32 v4, 4, v4
    v_lshl_add_u32 v4, v2, 13, v4
    v_xor_b32 v5, v2, v1
    v_lshlrev_b32 v5, 4, v5
    v_lshl_add_u32 v5, v2, 13, v5
    v_xor_b32 v6, 64, v5
    v_xor_b32 v54, 128, v5
    v_xor_b32 v55, 192, v5
    v_lshrrev_b32 v7, 5, v0
    v_mul_u32_u24 v7, 1280, v7
    v_and_b32 v8, 31, v0
    v_mad_u32_u24 v7, v8, 40, v7
    s_mul_i32 s54, s53, 1310720
    s_lshl_b32 s55, s45, 15
    s_add_u32 s54, s54, s55
    s_lshl_b32 s55, s46, 10
    s_add_u32 s54, s54, s55
    s_lshl_b32 s55, s51, 8
    s_add_u32 s54, s54, s55
    s_add_u32 s52, s52, s45
    s_lshl_b32 s55, s47, 18
    s_lshl_b32 s56, s52, 8
    s_add_u32 s55, s55, s56
    s_lshl_b32 s57, s45, 10
    s_mov_b32 m0, s57
    s_lshl_b32 s58, s45, 13
    s_add_u32 s58, s58, 49152
    s_lshl_b32 s59, s46, 14
    s_lshl_b32 s60, s47, 10
    s_add_u32 s59, s59, s60
    s_add_u32 s59, s59, 589824
    s_mov_b32 s34, 5242880
    s_mov_b32 s38, 4194304
    s_mov_b32 s42, 2560
    s_cmp_eq_u32 s45, 3
    s_waitcnt lgkmcnt(0)
    s_load_dword s44, s[26:27], 0
    s_mov_b64 s[40:41], s[4:5]
    s_mov_b64 s[32:33], s[8:9]
    s_mov_b64 s[28:29], s[26:27]
    s_cbranch_scc1 L_x3
    buffer_load_dwordx4 v3, s[40:43], s57 offen lds
    s_branch L_x0
L_x3:
    buffer_load_dwordx4 v[252:255], v3, s[28:31], s59 offen sc1
L_x0:
    s_add_u32 m0, s57, 8192
    s_cmp_lg_u32 s45, 3
    s_cbranch_scc1 L_x4
    v_bfe_u32 v44, v0, 2, 3
    v_lshlrev_b32 v44, 15, v44
    v_lshl_add_u32 v44, v9, 6, v44
    s_lshl_b32 s59, s47, 11
    s_lshl_b32 s60, s46, 8
    s_add_u32 s59, s59, s60
    s_add_u32 s59, s59, 3145728
    buffer_load_dword v251, v44, s[28:31], s59 offen sc1
L_x4:
    s_mov_b64 s[36:37], s[10:11]
    s_add_u32 s61, s57, 8192
    s_mov_b32 s57, 0xffff0000
    buffer_load_dwordx4 v4, s[32:35], s54 offen nt lds
    s_add_u32 s54, s54, 131072
    s_add_u32 m0, s61, 4096
    s_nop 0
    buffer_load_dwordx4 v4, s[32:35], s54 offen nt lds
    s_add_u32 s54, s54, 131072
    s_add_u32 m0, s61, 8192
    s_nop 0
    buffer_load_dwordx4 v4, s[32:35], s54 offen nt lds
    s_add_u32 s54, s54, 131072
    s_add_u32 m0, s61, 12288
    s_nop 0
    buffer_load_dwordx4 v4, s[32:35], s54 offen nt lds
    s_add_u32 s54, s54, 131072
    s_add_u32 m0, s61, 16384
    s_nop 0
    buffer_load_dwordx4 v4, s[32:35], s54 offen nt lds
    s_add_u32 s54, s54, 131072
    s_add_u32 m0, s61, 20480
    s_nop 0
    buffer_load_dwordx4 v4, s[32:35], s54 offen nt lds
    s_add_u32 s54, s54, 131072
    s_add_u32 m0, s61, 24576
    s_nop 0
    buffer_load_dwordx4 v4, s[32:35], s54 offen nt lds
    s_add_u32 s54, s54, 131072
    s_add_u32 m0, s61, 28672
    s_nop 0
    buffer_load_dwordx4 v4, s[32:35], s54 offen nt lds
    s_add_u32 s54, s54, 131072
    s_add_u32 m0, s61, 32768
    s_nop 0
    buffer_load_dwordx4 v4, s[32:35], s54 offen nt lds
    s_add_u32 s54, s54, 131072
    s_add_u32 m0, s61, 36864
    s_nop 0
    buffer_load_dwordx4 v4, s[32:35], s54 offen nt lds
    s_add_u32 m0, s58, 0
    s_nop 0
    buffer_load_dwordx4 v5, s[36:39], s55 offen nt lds
    s_add_u32 s55, s55, 32768
    s_waitcnt vmcnt(11) lgkmcnt(0)
    s_barrier
    s_not_b32 s44, s44
    ds_read_b64 v[12:13], v7 offset:0
    ds_read_b64 v[14:15], v7 offset:8
    ds_read_b64 v[16:17], v7 offset:16
    ds_read_b64 v[18:19], v7 offset:24
    ds_read_b64 v[46:47], v7 offset:32
    s_add_u32 m0, s58, 1024
    s_nop 0
    buffer_load_dwordx4 v6, s[36:39], s55 offen nt lds
    s_add_u32 s55, s55, 32768
    s_waitcnt lgkmcnt(0)
    v_lshlrev_b32 v20, 16, v12
    v_and_b32 v21, s57, v12
    v_lshlrev_b32 v22, 16, v13
    v_and_b32 v23, s57, v13
    v_lshlrev_b32 v24, 16, v14
    v_and_b32 v25, s57, v14
    v_lshlrev_b32 v26, 16, v15
    v_and_b32 v27, s57, v15
    v_lshlrev_b32 v28, 16, v16
    v_and_b32 v29, s57, v16
    v_lshlrev_b32 v30, 16, v17
    v_and_b32 v31, s57, v17
    v_lshlrev_b32 v32, 16, v18
    v_and_b32 v33, s57, v18
    v_lshlrev_b32 v34, 16, v19
    v_and_b32 v35, s57, v19
    v_lshlrev_b32 v36, 16, v46
    v_and_b32 v37, s57, v46
    v_lshlrev_b32 v38, 16, v47
    v_and_b32 v39, s57, v47
    s_add_u32 m0, s58, 2048
    s_nop 0
    buffer_load_dwordx4 v54, s[36:39], s55 offen nt lds
    s_add_u32 s55, s55, 32768
    v_pk_add_f32 v[40:41], v[20:21], v[22:23]
    v_pk_add_f32 v[42:43], v[24:25], v[26:27]
    v_pk_add_f32 v[40:41], v[40:41], v[28:29]
    v_pk_add_f32 v[42:43], v[42:43], v[30:31]
    v_pk_add_f32 v[40:41], v[40:41], v[32:33]
    v_pk_add_f32 v[42:43], v[42:43], v[34:35]
    v_pk_add_f32 v[40:41], v[40:41], v[36:37]
    v_pk_add_f32 v[42:43], v[42:43], v[38:39]
    v_pk_add_f32 v[40:41], v[40:41], v[42:43]
    v_add_f32 v40, v40, v41
    s_nop 1
    v_add_f32_dpp v40, v40, v40 quad_perm:[1,0,3,2] row_mask:0xf bank_mask:0xf
    s_nop 1
    v_add_f32_dpp v40, v40, v40 quad_perm:[2,3,0,1] row_mask:0xf bank_mask:0xf
    s_nop 1
    v_add_f32_dpp v40, v40, v40 row_half_mirror row_mask:0xf bank_mask:0xf
    s_nop 1
    v_add_f32_dpp v40, v40, v40 row_mirror row_mask:0xf bank_mask:0xf
    v_mov_b32 v41, v40
    s_nop 1
    v_permlane16_swap_b32 v40, v41
    v_add_f32 v40, v40, v41
    s_add_u32 m0, s58, 3072
    s_nop 0
    buffer_load_dwordx4 v55, s[36:39], s55 offen nt lds
    s_add_u32 s55, s55, 32768
    v_mul_f32 v40, 0xbacccccd, v40
    v_pk_add_f32 v[20:21], v[20:21], v[40:41] op_sel_hi:[1,0]
    v_pk_add_f32 v[22:23], v[22:23], v[40:41] op_sel_hi:[1,0]
    v_pk_add_f32 v[24:25], v[24:25], v[40:41] op_sel_hi:[1,0]
    v_pk_add_f32 v[26:27], v[26:27], v[40:41] op_sel_hi:[1,0]
    v_pk_add_f32 v[28:29], v[28:29], v[40:41] op_sel_hi:[1,0]
    v_pk_add_f32 v[30:31], v[30:31], v[40:41] op_sel_hi:[1,0]
    v_pk_add_f32 v[32:33], v[32:33], v[40:41] op_sel_hi:[1,0]
    v_pk_add_f32 v[34:35], v[34:35], v[40:41] op_sel_hi:[1,0]
    v_pk_add_f32 v[36:37], v[36:37], v[40:41] op_sel_hi:[1,0]
    v_pk_add_f32 v[38:39], v[38:39], v[40:41] op_sel_hi:[1,0]
    v_pk_mul_f32 v[42:43], v[20:21], v[20:21]
    v_pk_mul_f32 v[44:45], v[22:23], v[22:23]
    v_pk_fma_f32 v[42:43], v[24:25], v[24:25], v[42:43]
    v_pk_fma_f32 v[44:45], v[26:27], v[26:27], v[44:45]
    v_pk_fma_f32 v[42:43], v[28:29], v[28:29], v[42:43]
    v_pk_fma_f32 v[44:45], v[30:31], v[30:31], v[44:45]
    v_pk_fma_f32 v[42:43], v[32:33], v[32:33], v[42:43]
    v_pk_fma_f32 v[44:45], v[34:35], v[34:35], v[44:45]
    v_pk_fma_f32 v[42:43], v[36:37], v[36:37], v[42:43]
    v_pk_fma_f32 v[44:45], v[38:39], v[38:39], v[44:45]
    s_add_u32 m0, s58, 4096
    s_nop 0
    buffer_load_dwordx4 v5, s[36:39], s55 offen nt lds
    s_add_u32 s55, s55, 32768
    v_pk_add_f32 v[42:43], v[42:43], v[44:45]
    v_add_f32 v42, v42, v43
    s_nop 1
    v_add_f32_dpp v42, v42, v42 quad_perm:[1,0,3,2] row_mask:0xf bank_mask:0xf
    s_nop 1
    v_add_f32_dpp v42, v42, v42 quad_perm:[2,3,0,1] row_mask:0xf bank_mask:0xf
    s_nop 1
    v_add_f32_dpp v42, v42, v42 row_half_mirror row_mask:0xf bank_mask:0xf
    s_nop 1
    v_add_f32_dpp v42, v42, v42 row_mirror row_mask:0xf bank_mask:0xf
    v_mov_b32 v41, v42
    s_nop 1
    v_permlane16_swap_b32 v42, v41
    v_add_f32 v42, v42, v41
    v_mov_b32 v43, 0x3727c5ac
    v_fmac_f32 v43, 0x3acccccd, v42
    v_rsq_f32 v42, v43
    s_nop 0
    v_mul_f32 v42, 0x3e0293ee, v42
    s_add_u32 m0, s58, 5120
    s_nop 0
    buffer_load_dwordx4 v6, s[36:39], s55 offen nt lds
    s_add_u32 s55, s55, 32768
    v_pk_mul_f32 v[20:21], v[20:21], v[42:43] op_sel_hi:[1,0]
    v_pk_mul_f32 v[22:23], v[22:23], v[42:43] op_sel_hi:[1,0]
    v_pk_mul_f32 v[24:25], v[24:25], v[42:43] op_sel_hi:[1,0]
    v_pk_mul_f32 v[26:27], v[26:27], v[42:43] op_sel_hi:[1,0]
    v_pk_mul_f32 v[28:29], v[28:29], v[42:43] op_sel_hi:[1,0]
    v_pk_mul_f32 v[30:31], v[30:31], v[42:43] op_sel_hi:[1,0]
    v_pk_mul_f32 v[32:33], v[32:33], v[42:43] op_sel_hi:[1,0]
    v_pk_mul_f32 v[34:35], v[34:35], v[42:43] op_sel_hi:[1,0]
    v_pk_mul_f32 v[36:37], v[36:37], v[42:43] op_sel_hi:[1,0]
    v_pk_mul_f32 v[38:39], v[38:39], v[42:43] op_sel_hi:[1,0]
    v_cvt_pk_bf16_f32 v12, v20, v21
    v_cvt_pk_bf16_f32 v13, v22, v23
    v_cvt_pk_bf16_f32 v14, v24, v25
    v_cvt_pk_bf16_f32 v15, v26, v27
    v_cvt_pk_bf16_f32 v16, v28, v29
    v_cvt_pk_bf16_f32 v17, v30, v31
    v_cvt_pk_bf16_f32 v18, v32, v33
    v_cvt_pk_bf16_f32 v19, v34, v35
    v_cvt_pk_bf16_f32 v46, v36, v37
    v_cvt_pk_bf16_f32 v47, v38, v39
    ds_write_b64 v7, v[12:13] offset:4096
    ds_write_b64 v7, v[14:15] offset:4104
    ds_write_b64 v7, v[16:17] offset:4112
    ds_write_b64 v7, v[18:19] offset:4120
    ds_write_b64 v7, v[46:47] offset:4128
    s_add_u32 m0, s58, 6144
    s_nop 0
    buffer_load_dwordx4 v54, s[36:39], s55 offen nt lds
    s_add_u32 s55, s55, 32768
    v_lshlrev_b32 v44, 2, v9
    v_lshrrev_b32_e64 v48, v44, s44
    v_lshrrev_b32 v49, 1, v48
    v_lshrrev_b32 v50, 2, v48
    v_lshrrev_b32 v51, 3, v48
    v_bitop3_b32 v112, v48, v48, s48 bitop3:0x0a
    v_bitop3_b32 v113, v49, v49, s48 bitop3:0x0a
    v_bitop3_b32 v114, v50, v50, s48 bitop3:0x0a
    v_bitop3_b32 v115, v51, v51, s48 bitop3:0x0a
    v_lshrrev_b32_e64 v52, v1, s44
    v_bfe_u32 v44, v0, 1, 4
    v_and_b32 v45, 1, v0
    v_lshl_add_u32 v44, v45, 4, v44
    v_lshrrev_b32_e64 v53, v44, s44
    v_lshlrev_b32 v53, 16, v53
    v_mul_u32_u24 v8, 1280, v45
    v_lshl_add_u32 v8, v2, 4, v8
    s_mul_i32 s56, s53, 320
    v_add_u32 v8, s56, v8
    v_xor_b32 v11, s45, v10
    v_lshlrev_b32 v11, 6, v11
    v_lshl_add_u32 v11, v10, 8, v11
    v_lshl_add_u32 v11, v9, 4, v11
    v_lshl_add_u32 v11, v2, 11, v11
    v_lshlrev_b32 v12, 8, v2
    v_lshl_add_u32 v12, v1, 4, v12
    s_mov_b32 vcc_lo, 0x000f000f
    s_mov_b32 vcc_hi, 0x000f000f
    v_mov_b32 v44, 1073741824
    v_cndmask_b32 v12, v44, v12, vcc
    ds_read_b128 v[20:23], v8 offset:4096
    ds_read_b128 v[24:27], v8 offset:4160
    ds_read_b128 v[28:31], v8 offset:4224
    ds_read_b128 v[32:35], v8 offset:4288
    ds_read_b128 v[36:39], v8 offset:4352
    s_add_u32 m0, s58, 7168
    s_nop 0
    buffer_load_dwordx4 v55, s[36:39], s55 offen nt lds
    s_lshl_b32 s54, s51, 12
    s_lshl_b32 s55, s45, 10
    s_add_u32 s54, s54, s55
    s_lshl_b32 s55, s46, 14
    s_add_u32 s54, s54, s55
    s_lshl_b32 s55, s53, 6
    s_add_u32 s54, s54, s55
    s_add_u32 s54, s54, 65536
    s_add_u32 s56, s54, 524288
    s_lshl_b32 s55, s52, 12
    s_add_u32 s55, s55, 589824
    v_xor_b32 v13, v1, v2
    v_lshlrev_b32 v13, 4, v13
    v_lshl_add_u32 v13, v1, 8, v13
    v_add_u32 v13, s58, v13
    v_xor_b32 v14, 64, v13
    v_xor_b32 v15, 128, v13
    v_xor_b32 v16, 192, v13
    v_lshrrev_b32 v17, 5, v0
    v_lshlrev_b32 v17, 15, v17
    v_and_b32 v44, 31, v0
    v_lshl_add_u32 v17, v44, 1, v17
    s_lshl_b32 s59, s47, 11
    s_lshl_b32 s60, s52, 6
    s_add_u32 s59, s59, s60
    s_add_u32 s59, s59, 3145728
    s_mov_b32 vcc_lo, 0xcccccccc
    s_mov_b32 vcc_hi, 0xcccccccc
    v_mov_b32 v44, 0xfffe0000
    v_mov_b32 v45, 0x10000
    v_cndmask_b32 v18, 0, v44, vcc
    v_cndmask_b32 v19, 0, v45, vcc
    s_mov_b32 s60, 0x10000
    s_waitcnt vmcnt(12)
    s_barrier
    ds_read_b64_tr_b16 a[0:1], v11 offset:8192
    ds_read_b64_tr_b16 a[2:3], v11 offset:9216
    ds_read_b64_tr_b16 a[20:21], v11 offset:8200
    ds_read_b64_tr_b16 a[22:23], v11 offset:9224
    ds_read_b64_tr_b16 a[4:5], v11 offset:16384
    ds_read_b64_tr_b16 a[6:7], v11 offset:17408
    ds_read_b64_tr_b16 a[24:25], v11 offset:16392
    ds_read_b64_tr_b16 a[26:27], v11 offset:17416
    ds_read_b64_tr_b16 a[8:9], v11 offset:24576
    ds_read_b64_tr_b16 a[10:11], v11 offset:25600
    ds_read_b64_tr_b16 a[28:29], v11 offset:24584
    ds_read_b64_tr_b16 a[30:31], v11 offset:25608
    s_waitcnt lgkmcnt(8)
    v_mfma_f32_16x16x32_bf16 v[56:59], a[0:3], v[20:23], 0
    v_mfma_f32_16x16x32_bf16 v[60:63], a[20:23], v[20:23], 0
    s_waitcnt lgkmcnt(4)
    v_mfma_f32_16x16x32_bf16 v[56:59], a[4:7], v[24:27], v[56:59]
    v_mfma_f32_16x16x32_bf16 v[60:63], a[24:27], v[24:27], v[60:63]
    s_waitcnt lgkmcnt(0)
    v_mfma_f32_16x16x32_bf16 v[56:59], a[8:11], v[28:31], v[56:59]
    v_mfma_f32_16x16x32_bf16 v[60:63], a[28:31], v[28:31], v[60:63]
    s_waitcnt vmcnt(8)
    s_barrier
    ds_read_b64_tr_b16 a[12:13], v11 offset:32768
    ds_read_b64_tr_b16 a[14:15], v11 offset:33792
    ds_read_b64_tr_b16 a[32:33], v11 offset:32776
    ds_read_b64_tr_b16 a[34:35], v11 offset:33800
    ds_read_b64_tr_b16 a[16:17], v11 offset:40960
    ds_read_b64_tr_b16 a[18:19], v11 offset:41984
    ds_read_b64_tr_b16 a[36:37], v11 offset:40968
    ds_read_b64_tr_b16 a[38:39], v11 offset:41992
    s_waitcnt lgkmcnt(4)
    v_mfma_f32_16x16x32_bf16 v[56:59], a[12:15], v[32:35], v[56:59]
    v_mfma_f32_16x16x32_bf16 v[60:63], a[32:35], v[32:35], v[60:63]
    s_waitcnt lgkmcnt(0)
    v_mfma_f32_16x16x32_bf16 v[56:59], a[16:19], v[36:39], v[56:59]
    v_mfma_f32_16x16x32_bf16 v[60:63], a[36:39], v[36:39], v[60:63]
    s_nop 2
    v_mov_b32 v250, v0
    s_nop 2
    v_and_or_b32 v64, v56, v18, v19
    v_and_or_b32 v65, v57, v18, v19
    v_and_or_b32 v66, v58, v18, v19
    v_and_or_b32 v67, v59, v18, v19
    v_and_or_b32 v68, v60, v18, v19
    v_and_or_b32 v69, v61, v18, v19
    v_and_or_b32 v70, v62, v18, v19
    v_and_or_b32 v71, v63, v18, v19
    v_pk_add_f32 v[56:57], v[56:57], v[64:65] neg_lo:[0,1] neg_hi:[0,1]
    v_pk_add_f32 v[58:59], v[58:59], v[66:67] neg_lo:[0,1] neg_hi:[0,1]
    v_pk_add_f32 v[60:61], v[60:61], v[68:69] neg_lo:[0,1] neg_hi:[0,1]
    v_pk_add_f32 v[62:63], v[62:63], v[70:71] neg_lo:[0,1] neg_hi:[0,1]
    v_perm_b32 v64, v57, v56, s3
    v_perm_b32 v65, v59, v58, s3
    v_perm_b32 v66, v61, v60, s3
    v_perm_b32 v67, v63, v62, s3
    v_bfi_b32 v64, s48, v48, v64
    v_bfi_b32 v65, s48, v49, v65
    v_bfi_b32 v66, s48, v50, v66
    v_bfi_b32 v67, s48, v51, v67
    buffer_store_dwordx4 v[64:67], v12, s[28:31], s56 offen
    s_cmp_eq_u32 s45, 0
    s_cselect_b32 s49, 1, 0
    v_mov_b32 v54, 0
    s_mov_b32 vcc_lo, s49
    s_mov_b32 vcc_hi, 0
    v_mov_b32 v44, 1073741824
    v_cndmask_b32 v54, v44, v54, vcc
    v_mov_b32 v55, s44
    v_lshlrev_b32 v47, 2, v0
    s_lshl_b32 s62, s46, 7
    s_add_u32 s62, s62, 987136
    s_lshl_b32 s49, s47, 2
    s_add_u32 s62, s62, s49
    s_add_u32 s90, s59, 65536
    s_add_u32 s91, s59, 131072
    s_add_u32 s92, s59, 196608
    s_waitcnt vmcnt(1)
    buffer_load_dwordx4 v[72:75], v3, s[28:31], s55 offen offset:0 sc1
    buffer_load_dwordx4 v[76:79], v3, s[28:31], s55 offen offset:1024 sc1
    buffer_load_dwordx4 v[80:83], v3, s[28:31], s55 offen offset:2048 sc1
    buffer_load_dwordx4 v[84:87], v3, s[28:31], s55 offen offset:3072 sc1
    s_waitcnt vmcnt(5)
    ds_read_b128 a[40:43], v13 offset:0
    ds_read_b128 a[56:59], v13 offset:4096
    ds_read_b128 a[44:47], v14 offset:0
    ds_read_b128 a[60:63], v14 offset:4096
    ds_read_b128 a[48:51], v15 offset:0
    ds_read_b128 a[64:67], v15 offset:4096
    ds_read_b128 a[52:55], v16 offset:0
    ds_read_b128 a[68:71], v16 offset:4096
    s_mov_b32 s50, 0
    s_branch L_pollB_chk
L_pollB:
    s_cmp_gt_u32 s50, 256
    s_cselect_b32 s49, 524288, 0
    s_xor_b32 s55, s55, s49
    buffer_load_dwordx4 v[72:75], v3, s[28:31], s55 offen offset:0 sc1
    buffer_load_dwordx4 v[76:79], v3, s[28:31], s55 offen offset:1024 sc1
    buffer_load_dwordx4 v[80:83], v3, s[28:31], s55 offen offset:2048 sc1
    buffer_load_dwordx4 v[84:87], v3, s[28:31], s55 offen offset:3072 sc1
    s_add_u32 s50, s50, 1
    s_cmp_gt_u32 s50, 40000
    s_cbranch_scc1 L_fail
    s_cmp_lg_u32 s50, 256
    s_cbranch_scc1 L_pollB_chk
    buffer_store_dwordx4 v[64:67], v12, s[28:31], s54 offen sc1
    s_waitcnt vmcnt(0)
L_pollB_chk:
    s_waitcnt vmcnt(3)
    v_xor_b32 v72, v72, v112
    v_xor_b32 v73, v73, v113
    v_xor_b32 v74, v74, v114
    v_xor_b32 v75, v75, v115
    v_bitop3_b32 v44, v72, v73, s48 bitop3:0x80
    v_bitop3_b32 v44, v44, v74, v75 bitop3:0x80
    s_waitcnt lgkmcnt(0)
    v_mfma_f32_16x16x32_bf16 v[56:59], v[72:75], a[40:43], 0
    v_mfma_f32_16x16x32_bf16 v[60:63], v[72:75], a[56:59], 0
    s_waitcnt vmcnt(2)
    v_xor_b32 v76, v76, v112
    v_xor_b32 v77, v77, v113
    v_xor_b32 v78, v78, v114
    v_xor_b32 v79, v79, v115
    v_bitop3_b32 v44, v76, v77, v44 bitop3:0x80
    v_bitop3_b32 v44, v44, v78, v79 bitop3:0x80
    v_mfma_f32_16x16x32_bf16 v[56:59], v[76:79], a[44:47], v[56:59]
    v_mfma_f32_16x16x32_bf16 v[60:63], v[76:79], a[60:63], v[60:63]
    s_waitcnt vmcnt(1)
    v_xor_b32 v80, v80, v112
    v_xor_b32 v81, v81, v113
    v_xor_b32 v82, v82, v114
    v_xor_b32 v83, v83, v115
    v_bitop3_b32 v44, v80, v81, v44 bitop3:0x80
    v_bitop3_b32 v44, v44, v82, v83 bitop3:0x80
    v_mfma_f32_16x16x32_bf16 v[56:59], v[80:83], a[48:51], v[56:59]
    v_mfma_f32_16x16x32_bf16 v[60:63], v[80:83], a[64:67], v[60:63]
    s_waitcnt vmcnt(0)
    v_xor_b32 v84, v84, v112
    v_xor_b32 v85, v85, v113
    v_xor_b32 v86, v86, v114
    v_xor_b32 v87, v87, v115
    v_bitop3_b32 v44, v84, v85, v44 bitop3:0x80
    v_bitop3_b32 v44, v44, v86, v87 bitop3:0x80
    v_mfma_f32_16x16x32_bf16 v[56:59], v[84:87], a[52:55], v[56:59]
    v_mfma_f32_16x16x32_bf16 v[60:63], v[84:87], a[68:71], v[60:63]
    v_cmp_ne_u32 vcc, s48, v44
    s_cbranch_vccnz L_pollB
L_pollB_ok:
    s_barrier
    buffer_store_dword v55, v54, s[28:31], s62 offen
    s_nop 2
    v_pk_add_f32 v[56:57], v[56:57], v[58:59]
    v_pk_add_f32 v[60:61], v[60:61], v[62:63]
    s_nop 0
    v_permlane32_swap_b32 v56, v57
    v_permlane32_swap_b32 v60, v61
    v_add_f32 v56, v56, v57
    v_add_f32 v60, v60, v61
    s_nop 1
    v_permlane16_swap_b32 v56, v60
    v_add_f32 v56, v56, v60
    v_bfi_b32 v56, s60, v53, v56
    buffer_store_short_d16_hi v56, v17, s[28:31], s59 offen sc1
    buffer_store_short_d16_hi v56, v17, s[28:31], s90 offen sc1
    buffer_store_short_d16_hi v56, v17, s[28:31], s91 offen sc1
    buffer_store_short_d16_hi v56, v17, s[28:31], s92 offen sc1
    buffer_store_dwordx4 v[64:67], v12, s[28:31], s54 offen sc1
    s_cmp_lt_u32 s47, 10
    s_cbranch_scc1 L_E
    s_sub_u32 s61, s47, 10
    s_lshl_b32 s61, s61, 3
    s_add_u32 s61, s61, s46
    s_cmp_lt_u32 s61, 27
    s_cbranch_scc1 L_FG
    s_sub_u32 s61, s61, 27
    s_cmp_lg_u32 s45, 0
    s_cbranch_scc1 L_done
    s_cmp_ge_u32 s61, 20
    s_cbranch_scc1 L_done
    v_bfe_u32 v44, v1, 2, 1
    v_lshlrev_b32 v44, 4, v44
    v_mov_b32 v45, 0x3f80
    v_lshlrev_b32 v44, v44, v45
    s_mov_b32 vcc_lo, 0x110011
    s_mov_b32 vcc_hi, vcc_lo
    v_cndmask_b32 v56, 0, v44, vcc
    s_mov_b32 vcc_lo, 0x220022
    s_mov_b32 vcc_hi, vcc_lo
    v_cndmask_b32 v57, 0, v44, vcc
    s_mov_b32 vcc_lo, 0x440044
    s_mov_b32 vcc_hi, vcc_lo
    v_cndmask_b32 v58, 0, v44, vcc
    s_mov_b32 vcc_lo, 0x880088
    s_mov_b32 vcc_hi, vcc_lo
    v_cndmask_b32 v59, 0, v44, vcc
    s_mov_b32 vcc_lo, 0x11001100
    s_mov_b32 vcc_hi, vcc_lo
    v_cndmask_b32 v60, 0, v44, vcc
    s_mov_b32 vcc_lo, 0x22002200
    s_mov_b32 vcc_hi, vcc_lo
    v_cndmask_b32 v61, 0, v44, vcc
    s_mov_b32 vcc_lo, 0x44004400
    s_mov_b32 vcc_hi, vcc_lo
    v_cndmask_b32 v62, 0, v44, vcc
    s_mov_b32 vcc_lo, 0x88008800
    s_mov_b32 vcc_hi, vcc_lo
    v_cndmask_b32 v63, 0, v44, vcc
    s_mov_b32 s32, s22
    s_mov_b32 s33, s23
    s_mov_b32 s34, 2560
    v_lshrrev_b32 v4, 3, v0
    v_lshlrev_b32 v4, 8, v4
    v_and_b32 v5, 7, v0
    v_lshl_add_u32 v4, v5, 4, v4
    s_lshr_b32 s54, s61, 1
    s_lshl_b32 s54, s54, 11
    s_and_b32 s55, s61, 1
    s_lshl_b32 s55, s55, 7
    s_add_u32 s54, s54, s55
    s_add_u32 s54, s54, 3407872
    s_lshl_b32 s55, s61, 12
    s_add_u32 s55, s55, 425984
    v_mul_u32_u24 v6, 1280, v2
    v_lshl_add_u32 v6, v1, 3, v6
    s_lshl_b32 s56, s61, 6
    s_mov_b32 vcc_lo, 0x00ff00ff
    s_mov_b32 vcc_hi, 0
    v_mov_b32 v44, 1073741824
    v_cndmask_b32 v6, v44, v6, vcc
    v_mov_b32 v5, v3
    s_mov_b32 vcc_lo, 0x00ffffff
    s_mov_b32 vcc_hi, 0
    v_mov_b32 v44, 1073741824
    v_cndmask_b32 v5, v44, v5, vcc
    v_mov_b32 v44, s48
    v_cndmask_b32 v116, v44, v112, vcc
    v_cndmask_b32 v117, v44, v113, vcc
    v_cndmask_b32 v118, v44, v114, vcc
    v_cndmask_b32 v119, v44, v115, vcc
    v_lshlrev_b32 v40, 2, v1
    v_min_u32 v41, 9, v1
    v_lshlrev_b32 v41, 2, v41
    v_and_b32 v43, 7, v0
    v_lshlrev_b32 v43, 7, v43
    s_lshl_b32 s62, s46, 7
    s_add_u32 s62, s62, 991232
    s_mov_b32 s50, 0
L_gRa:
    buffer_load_dword v42, v41, s[28:31], s62 offen sc1
    s_add_u32 s50, s50, 1
    s_cmp_gt_u32 s50, 256
    s_cbranch_scc1 L_gRa_go
L_gRa_chk:
    s_waitcnt vmcnt(0)
    v_bitop3_b32 v42, v42, v42, s44 bitop3:0x7e
    v_cmp_ne_u32 vcc, 0, v42
    s_cbranch_vccnz L_gRa
L_gRa_go:
    s_mov_b32 s50, 0
L_pollR1:
    buffer_load_dwordx4 v[68:71], v4, s[28:31], s54 offen offset:0 sc1
    s_add_u32 s50, s50, 1
    s_cmp_gt_u32 s50, 40000
    s_cbranch_scc1 L_fail
L_pollR1_chk:
    s_waitcnt vmcnt(0)
    v_xor_b32 v68, v68, v112
    v_xor_b32 v69, v69, v113
    v_xor_b32 v70, v70, v114
    v_xor_b32 v71, v71, v115
    v_bitop3_b32 v44, v68, v69, s48 bitop3:0x80
    v_bitop3_b32 v44, v44, v70, v71 bitop3:0x80
    v_cmp_ne_u32 vcc, s48, v44
    s_cbranch_vccnz L_pollR1
L_pollR1_ok:
    v_mfma_f32_16x16x32_bf16 v[64:67], v[56:59], v[68:71], 0
    s_lshl_b32 s62, s46, 7
    s_add_u32 s62, s62, 995328
    s_mov_b64 exec, 0x3ff
    s_mov_b32 s50, 0
L_hintR2:
    buffer_load_dword v28, v47, s[28:31], s62 offen sc1
    s_add_u32 s50, s50, 1
    s_cmp_gt_u32 s50, 64
    s_cbranch_scc1 L_hintR2_go
L_hintR2_chk:
    s_waitcnt vmcnt(0)
    v_cmp_ne_u32 vcc, s44, v28
    s_cbranch_vccnz L_hintR2
L_hintR2_go:
    s_mov_b64 exec, -1
    s_mov_b32 s50, 0
L_pollR2:
    buffer_load_dwordx4 v[72:75], v3, s[28:31], s55 offen offset:0 sc1
    buffer_load_dwordx4 v[76:79], v3, s[28:31], s55 offen offset:1024 sc1
    buffer_load_dwordx4 v[80:83], v3, s[28:31], s55 offen offset:2048 sc1
    buffer_load_dwordx4 v[84:87], v5, s[28:31], s55 offen offset:3072 sc1
    s_add_u32 s50, s50, 1
    s_cmp_gt_u32 s50, 40000
    s_cbranch_scc1 L_fail
L_pollR2_chk:
    s_waitcnt vmcnt(3)
    v_xor_b32 v72, v72, v112
    v_xor_b32 v73, v73, v113
    v_xor_b32 v74, v74, v114
    v_xor_b32 v75, v75, v115
    v_bitop3_b32 v44, v72, v73, s48 bitop3:0x80
    v_bitop3_b32 v44, v44, v74, v75 bitop3:0x80
    v_mfma_f32_16x16x32_bf16 v[88:91], v[56:59], v[72:75], v[64:67]
    s_waitcnt vmcnt(2)
    v_xor_b32 v76, v76, v112
    v_xor_b32 v77, v77, v113
    v_xor_b32 v78, v78, v114
    v_xor_b32 v79, v79, v115
    v_bitop3_b32 v44, v76, v77, v44 bitop3:0x80
    v_bitop3_b32 v44, v44, v78, v79 bitop3:0x80
    v_mfma_f32_16x16x32_bf16 v[88:91], v[56:59], v[76:79], v[88:91]
    s_waitcnt vmcnt(1)
    v_xor_b32 v80, v80, v112
    v_xor_b32 v81, v81, v113
    v_xor_b32 v82, v82, v114
    v_xor_b32 v83, v83, v115
    v_bitop3_b32 v44, v80, v81, v44 bitop3:0x80
    v_bitop3_b32 v44, v44, v82, v83 bitop3:0x80
    v_mfma_f32_16x16x32_bf16 v[88:91], v[56:59], v[80:83], v[88:91]
    s_waitcnt vmcnt(0)
    v_xor_b32 v84, v84, v116
    v_xor_b32 v85, v85, v117
    v_xor_b32 v86, v86, v118
    v_xor_b32 v87, v87, v119
    v_bitop3_b32 v44, v84, v85, v44 bitop3:0x80
    v_bitop3_b32 v44, v44, v86, v87 bitop3:0x80
    v_mfma_f32_16x16x32_bf16 v[88:91], v[56:59], v[84:87], v[88:91]
    v_cmp_ne_u32 vcc, s48, v44
    s_cbranch_vccnz L_pollR2
L_pollR2_ok:
    s_nop 2
    v_mov_b32 v250, v0
    s_nop 1
    v_add_f32_dpp v64, v88, v88 row_ror:8 row_mask:0xf bank_mask:0xf
    v_add_f32_dpp v65, v89, v89 row_ror:8 row_mask:0xf bank_mask:0xf
    v_add_f32_dpp v66, v90, v90 row_ror:8 row_mask:0xf bank_mask:0xf
    v_add_f32_dpp v67, v91, v91 row_ror:8 row_mask:0xf bank_mask:0xf
    v_cvt_pk_bf16_f32 v64, v64, v65
    v_cvt_pk_bf16_f32 v65, v66, v67
    buffer_store_dwordx2 v[64:65], v6, s[32:35], s56 offen
    s_branch L_done
L_E:
    s_waitcnt vmcnt(0)
    s_mov_b32 s32, s14
    s_mov_b32 s33, s15
    s_mov_b32 s34, 5242880
    v_lshrrev_b32 v4, 3, v0
    v_and_b32 v5, 2, v4
    v_and_b32 v6, 7, v0
    v_xor_b32 v5, v5, v6
    v_lshlrev_b32 v5, 4, v5
    s_movk_i32 s54, 1280
    v_mad_u32_u24 v4, v4, s54, v5
    v_lshlrev_b32 v7, 9, v2
    v_lshl_add_u32 v7, v1, 4, v7
    s_lshl_b32 s57, s52, 11
    s_add_u32 s57, s57, 851968
    s_lshl_b32 s56, s47, 7
    s_lshl_b32 s55, s45, 5
    s_add_u32 s55, s55, s56
    v_lshl_add_u32 v13, v1, 1, s55
    ds_read_u16 v14, v13 offset:0
    ds_read_u16 v15, v13 offset:1280
    buffer_load_dwordx4 v[72:75], v7, s[28:31], s57 offen sc1
    buffer_load_dwordx4 v[76:79], v7, s[28:31], s57 offen offset:256 sc1
    s_mul_i32 s54, s52, 163840
    s_add_u32 s54, s54, s56
    s_mul_i32 s55, s45, 17408
    s_add_u32 m0, s55, 81920
    s_nop 0
    buffer_load_dwordx4 v4, s[32:35], s54 offen nt lds
    s_add_u32 m0, m0, 1088
    s_add_u32 s54, s54, 10240
    buffer_load_dwordx4 v4, s[32:35], s54 offen nt lds
    s_add_u32 m0, m0, 1088
    s_add_u32 s54, s54, 10240
    buffer_load_dwordx4 v4, s[32:35], s54 offen nt lds
    s_add_u32 m0, m0, 1088
    s_add_u32 s54, s54, 10240
    buffer_load_dwordx4 v4, s[32:35], s54 offen nt lds
    s_add_u32 m0, m0, 1088
    s_add_u32 s54, s54, 10240
    s_lshl_b32 s62, s46, 7
    s_add_u32 s62, s62, 983040
    s_lshl_b32 s49, s47, 2
    s_add_u32 s62, s62, s49
    s_cmp_lg_u32 s45, 3
    s_cbranch_scc1 L_hintE_go
    s_mov_b64 exec, 1
    s_mov_b32 s50, 0
L_hintE:
    buffer_load_dword v28, v3, s[28:31], s62 offen sc1
    s_add_u32 s50, s50, 1
    s_cmp_gt_u32 s50, 64
    s_cbranch_scc1 L_hintE_go
L_hintE_chk:
    s_waitcnt vmcnt(0)
    v_cmp_ne_u32 vcc, s44, v28
    s_cbranch_vccnz L_hintE
L_hintE_go:
    s_mov_b64 exec, -1
    s_barrier
    buffer_load_dwordx4 v4, s[32:35], s54 offen nt lds
    s_add_u32 m0, m0, 1088
    s_add_u32 s54, s54, 10240
    buffer_load_dwordx4 v4, s[32:35], s54 offen nt lds
    s_add_u32 m0, m0, 1088
    s_add_u32 s54, s54, 10240
    buffer_load_dwordx4 v4, s[32:35], s54 offen nt lds
    s_add_u32 m0, m0, 1088
    s_add_u32 s54, s54, 10240
    buffer_load_dwordx4 v4, s[32:35], s54 offen nt lds
    s_add_u32 m0, m0, 1088
    s_add_u32 s54, s54, 10240
    buffer_load_dwordx4 v4, s[32:35], s54 offen nt lds
    s_add_u32 m0, m0, 1088
    s_add_u32 s54, s54, 10240
    buffer_load_dwordx4 v4, s[32:35], s54 offen nt lds
    s_add_u32 m0, m0, 1088
    s_add_u32 s54, s54, 10240
    buffer_load_dwordx4 v4, s[32:35], s54 offen nt lds
    s_add_u32 m0, m0, 1088
    s_add_u32 s54, s54, 10240
    buffer_load_dwordx4 v4, s[32:35], s54 offen nt lds
    s_add_u32 m0, m0, 1088
    s_add_u32 s54, s54, 10240
    buffer_load_dwordx4 v4, s[32:35], s54 offen nt lds
    s_add_u32 m0, m0, 1088
    s_add_u32 s54, s54, 10240
    buffer_load_dwordx4 v4, s[32:35], s54 offen nt lds
    s_add_u32 m0, m0, 1088
    s_add_u32 s54, s54, 10240
    buffer_load_dwordx4 v4, s[32:35], s54 offen nt lds
    s_add_u32 m0, m0, 1088
    s_add_u32 s54, s54, 10240
    buffer_load_dwordx4 v4, s[32:35], s54 offen nt lds
    v_bfe_u32 v44, v1, 2, 1
    v_lshlrev_b32 v44, 4, v44
    v_mov_b32 v45, 0x3f80
    v_lshlrev_b32 v44, v44, v45
    s_mov_b32 vcc_lo, 0x110011
    s_mov_b32 vcc_hi, vcc_lo
    v_cndmask_b32 v56, 0, v44, vcc
    s_mov_b32 vcc_lo, 0x220022
    s_mov_b32 vcc_hi, vcc_lo
    v_cndmask_b32 v57, 0, v44, vcc
    s_mov_b32 vcc_lo, 0x440044
    s_mov_b32 vcc_hi, vcc_lo
    v_cndmask_b32 v58, 0, v44, vcc
    s_mov_b32 vcc_lo, 0x880088
    s_mov_b32 vcc_hi, vcc_lo
    v_cndmask_b32 v59, 0, v44, vcc
    s_mov_b32 vcc_lo, 0x11001100
    s_mov_b32 vcc_hi, vcc_lo
    v_cndmask_b32 v60, 0, v44, vcc
    s_mov_b32 vcc_lo, 0x22002200
    s_mov_b32 vcc_hi, vcc_lo
    v_cndmask_b32 v61, 0, v44, vcc
    s_mov_b32 vcc_lo, 0x44004400
    s_mov_b32 vcc_hi, vcc_lo
    v_cndmask_b32 v62, 0, v44, vcc
    s_mov_b32 vcc_lo, 0x88008800
    s_mov_b32 vcc_hi, vcc_lo
    v_cndmask_b32 v63, 0, v44, vcc
    v_lshrrev_b32 v5, 1, v10
    v_xor_b32 v5, s45, v5
    v_lshlrev_b32 v5, 5, v5
    v_lshl_add_u32 v5, v10, 7, v5
    v_lshl_add_u32 v5, v9, 3, v5
    s_movk_i32 s54, 1088
    v_mad_u32_u24 v5, v2, s54, v5
    v_add_u32 v5, 81920, v5
    v_add_u32 v6, 512, v5
    v_and_b32 v8, 1, v2
    v_mul_u32_u24 v8, 1152, v8
    v_lshrrev_b32 v11, 1, v2
    v_lshl_add_u32 v8, v11, 7, v8
    v_lshl_add_u32 v8, v1, 3, v8
    s_lshl_b32 s55, s45, 8
    v_add_u32 v8, s55, v8
    v_and_b32 v11, 1, v1
    v_mul_u32_u24 v11, 1152, v11
    v_bfe_u32 v12, v1, 1, 1
    v_lshl_add_u32 v11, v12, 6, v11
    v_lshl_add_u32 v11, v2, 4, v11
    v_lshlrev_b32 v12, 2, v1
    s_lshl_b32 s55, s47, 11
    s_lshl_b32 s56, s46, 8
    s_add_u32 s55, s55, s56
    s_lshl_b32 s56, s45, 6
    s_add_u32 s55, s55, s56
    s_add_u32 s55, s55, 3407872
    s_cmp_eq_u32 s46, 0
    s_cselect_b32 s56, -1, 0
    s_mov_b32 vcc_lo, 0xffff
    s_mov_b32 vcc_hi, 0
    v_mov_b32 v44, 1073741824
    v_cndmask_b32 v12, v44, v12, vcc
    buffer_load_dword v80, v12, s[28:31], s55 offen sc1
    s_waitcnt lgkmcnt(0)
    v_lshlrev_b32 v64, 16, v14
    v_lshlrev_b32 v65, 16, v15
    v_and_b32 v64, s56, v64
    v_and_b32 v65, s56, v65
    v_mov_b32 v66, 0
    v_mov_b32 v67, 0
    s_waitcnt vmcnt(0)
    s_barrier
    ds_read_b64_tr_b16 a[0:1], v5 offset:0
    ds_read_b64_tr_b16 a[2:3], v6 offset:0
    ds_read_b64_tr_b16 a[4:5], v5 offset:4352
    ds_read_b64_tr_b16 a[6:7], v6 offset:4352
    ds_read_b64_tr_b16 a[8:9], v5 offset:8704
    ds_read_b64_tr_b16 a[10:11], v6 offset:8704
    ds_read_b64_tr_b16 a[12:13], v5 offset:13056
    ds_read_b64_tr_b16 a[14:15], v6 offset:13056
    ds_read_b64_tr_b16 a[16:17], v5 offset:17408
    ds_read_b64_tr_b16 a[18:19], v6 offset:17408
    ds_read_b64_tr_b16 a[20:21], v5 offset:21760
    ds_read_b64_tr_b16 a[22:23], v6 offset:21760
    ds_read_b64_tr_b16 a[24:25], v5 offset:26112
    ds_read_b64_tr_b16 a[26:27], v6 offset:26112
    ds_read_b64_tr_b16 a[28:29], v5 offset:30464
    ds_read_b64_tr_b16 a[30:31], v6 offset:30464
    ds_read_b64_tr_b16 a[32:33], v5 offset:34816
    ds_read_b64_tr_b16 a[34:35], v6 offset:34816
    ds_read_b64_tr_b16 a[36:37], v5 offset:39168
    ds_read_b64_tr_b16 a[38:39], v6 offset:39168
    ds_read_b64_tr_b16 a[40:41], v5 offset:43520
    ds_read_b64_tr_b16 a[42:43], v6 offset:43520
    ds_read_b64_tr_b16 a[44:45], v5 offset:47872
    ds_read_b64_tr_b16 a[46:47], v6 offset:47872
    ds_read_b64_tr_b16 a[48:49], v5 offset:52224
    ds_read_b64_tr_b16 a[50:51], v6 offset:52224
    ds_read_b64_tr_b16 a[52:53], v5 offset:56576
    ds_read_b64_tr_b16 a[54:55], v6 offset:56576
    ds_read_b64_tr_b16 a[56:57], v5 offset:60928
    ds_read_b64_tr_b16 a[58:59], v6 offset:60928
    ds_read_b64_tr_b16 a[60:61], v5 offset:65280
    ds_read_b64_tr_b16 a[62:63], v6 offset:65280
    s_lshl_b32 s62, s46, 7
    s_add_u32 s62, s62, 991232
    s_lshl_b32 s49, s47, 2
    s_add_u32 s62, s62, s49
    s_mov_b32 s50, 0
L_pollE:
    s_cmp_gt_u32 s50, 256
    s_cselect_b32 s49, 524288, 0
    s_xor_b32 s57, s57, s49
    buffer_load_dwordx4 v[72:75], v7, s[28:31], s57 offen offset:0 sc1
    buffer_load_dwordx4 v[76:79], v7, s[28:31], s57 offen offset:256 sc1
    s_add_u32 s50, s50, 1
    s_cmp_gt_u32 s50, 40000
    s_cbranch_scc1 L_fail
L_pollE_chk:
    s_waitcnt vmcnt(1)
    v_xor_b32 v72, v72, v112
    v_xor_b32 v73, v73, v113
    v_xor_b32 v74, v74, v114
    v_xor_b32 v75, v75, v115
    v_bitop3_b32 v44, v72, v73, s48 bitop3:0x80
    v_bitop3_b32 v44, v44, v74, v75 bitop3:0x80
    v_mfma_f32_16x16x32_bf16 v[68:71], v[56:59], v[72:75], 0
    s_waitcnt vmcnt(0)
    v_xor_b32 v76, v76, v112
    v_xor_b32 v77, v77, v113
    v_xor_b32 v78, v78, v114
    v_xor_b32 v79, v79, v115
    v_bitop3_b32 v44, v76, v77, v44 bitop3:0x80
    v_bitop3_b32 v44, v44, v78, v79 bitop3:0x80
    v_mfma_f32_16x16x32_bf16 v[68:71], v[60:63], v[76:79], v[68:71]
    v_cmp_ne_u32 vcc, s48, v44
    s_cbranch_vccnz L_pollE
L_pollE_ok:
    s_nop 2
    v_mov_b32 v250, v0
    s_nop 1
    v_cvt_pk_bf16_f32 v44, v68, v69
    v_cvt_pk_bf16_f32 v45, v70, v71
    ds_write_b64 v8, v[44:45] offset:8192
    s_waitcnt lgkmcnt(0)
    s_barrier
    ds_read_b128 v[80:83], v11 offset:8192
    ds_read_b128 v[84:87], v11 offset:8320
    ds_read_b128 v[88:91], v11 offset:8448
    ds_read_b128 v[92:95], v11 offset:8576
    ds_read_b128 v[96:99], v11 offset:8704
    ds_read_b128 v[100:103], v11 offset:8832
    ds_read_b128 v[104:107], v11 offset:8960
    ds_read_b128 v[108:111], v11 offset:9088
    s_waitcnt lgkmcnt(7)
    v_mfma_f32_16x16x32_bf16 v[64:67], v[80:83], a[0:3], v[64:67]
    v_mfma_f32_16x16x32_bf16 v[68:71], v[80:83], a[4:7], 0
    s_waitcnt lgkmcnt(6)
    v_mfma_f32_16x16x32_bf16 v[64:67], v[84:87], a[8:11], v[64:67]
    v_mfma_f32_16x16x32_bf16 v[68:71], v[84:87], a[12:15], v[68:71]
    s_waitcnt lgkmcnt(5)
    v_mfma_f32_16x16x32_bf16 v[64:67], v[88:91], a[16:19], v[64:67]
    v_mfma_f32_16x16x32_bf16 v[68:71], v[88:91], a[20:23], v[68:71]
    s_waitcnt lgkmcnt(4)
    v_mfma_f32_16x16x32_bf16 v[64:67], v[92:95], a[24:27], v[64:67]
    v_mfma_f32_16x16x32_bf16 v[68:71], v[92:95], a[28:31], v[68:71]
    s_waitcnt lgkmcnt(3)
    v_mfma_f32_16x16x32_bf16 v[64:67], v[96:99], a[32:35], v[64:67]
    v_mfma_f32_16x16x32_bf16 v[68:71], v[96:99], a[36:39], v[68:71]
    s_waitcnt lgkmcnt(2)
    v_mfma_f32_16x16x32_bf16 v[64:67], v[100:103], a[40:43], v[64:67]
    v_mfma_f32_16x16x32_bf16 v[68:71], v[100:103], a[44:47], v[68:71]
    s_waitcnt lgkmcnt(1)
    v_mfma_f32_16x16x32_bf16 v[64:67], v[104:107], a[48:51], v[64:67]
    v_mfma_f32_16x16x32_bf16 v[68:71], v[104:107], a[52:55], v[68:71]
    s_waitcnt lgkmcnt(0)
    v_mfma_f32_16x16x32_bf16 v[64:67], v[108:111], a[56:59], v[64:67]
    v_mfma_f32_16x16x32_bf16 v[68:71], v[108:111], a[60:63], v[68:71]
    s_nop 2
    v_mov_b32 v250, v0
    s_nop 2
    v_mov_b32 v250, v0
    v_add_f32 v64, v64, v70
    v_add_f32 v65, v65, v71
    v_perm_b32 v64, v65, v64, s3
    v_bfi_b32 v64, s48, v52, v64
    buffer_store_dword v55, v54, s[28:31], s62 offen
    buffer_store_dword v64, v12, s[28:31], s55 offen sc1
    s_branch L_done
L_FG:
    s_mov_b32 s32, s18
    s_mov_b32 s33, s19
    s_mov_b32 s34, 2211840
    v_lshrrev_b32 v4, 3, v0
    v_and_b32 v5, 2, v4
    v_and_b32 v6, 7, v0
    v_xor_b32 v5, v5, v6
    v_lshlrev_b32 v5, 4, v5
    v_lshlrev_b32 v31, 8, v4
    v_lshl_add_u32 v31, v6, 4, v31
    s_movk_i32 s54, 3456
    v_mad_u32_u24 v4, v4, s54, v5
    s_mul_i32 s56, s45, 27648
    s_lshl_b32 s57, s61, 7
    s_add_u32 s56, s56, s57
    s_mul_i32 s57, s45, 1088
    s_add_u32 m0, s57, 16384
    s_nop 0
    buffer_load_dwordx4 v4, s[32:35], s56 offen nt lds
    s_add_u32 m0, m0, 4352
    s_add_u32 s56, s56, 110592
    buffer_load_dwordx4 v4, s[32:35], s56 offen nt lds
    s_add_u32 m0, m0, 4352
    s_add_u32 s56, s56, 110592
    buffer_load_dwordx4 v4, s[32:35], s56 offen nt lds
    s_add_u32 m0, m0, 4352
    s_add_u32 s56, s56, 110592
    buffer_load_dwordx4 v4, s[32:35], s56 offen nt lds
    s_add_u32 m0, m0, 4352
    s_add_u32 s56, s56, 110592
    buffer_load_dwordx4 v4, s[32:35], s56 offen nt lds
    s_add_u32 m0, m0, 4352
    s_add_u32 s56, s56, 110592
    buffer_load_dwordx4 v4, s[32:35], s56 offen nt lds
    s_add_u32 m0, m0, 4352
    s_add_u32 s56, s56, 110592
    buffer_load_dwordx4 v4, s[32:35], s56 offen nt lds
    s_add_u32 m0, m0, 4352
    s_add_u32 s56, s56, 110592
    buffer_load_dwordx4 v4, s[32:35], s56 offen nt lds
    s_add_u32 m0, m0, 4352
    s_add_u32 s56, s56, 110592
    buffer_load_dwordx4 v4, s[32:35], s56 offen nt lds
    s_add_u32 m0, m0, 4352
    s_add_u32 s56, s56, 110592
    buffer_load_dwordx4 v4, s[32:35], s56 offen nt lds
    s_add_u32 m0, m0, 4352
    s_add_u32 s56, s56, 110592
    buffer_load_dwordx4 v4, s[32:35], s56 offen nt lds
    s_add_u32 m0, m0, 4352
    s_add_u32 s56, s56, 110592
    buffer_load_dwordx4 v4, s[32:35], s56 offen nt lds
    s_add_u32 m0, m0, 4352
    s_add_u32 s56, s56, 110592
    buffer_load_dwordx4 v4, s[32:35], s56 offen nt lds
    s_add_u32 m0, m0, 4352
    s_add_u32 s56, s56, 110592
    buffer_load_dwordx4 v4, s[32:35], s56 offen nt lds
    s_add_u32 m0, m0, 4352
    s_add_u32 s56, s56, 110592
    buffer_load_dwordx4 v4, s[32:35], s56 offen nt lds
    s_add_u32 m0, m0, 4352
    s_add_u32 s56, s56, 110592
    buffer_load_dwordx4 v4, s[32:35], s56 offen nt lds
    s_add_u32 m0, m0, 4352
    s_add_u32 s56, s56, 110592
    buffer_load_dwordx4 v4, s[32:35], s56 offen nt lds
    s_add_u32 m0, m0, 4352
    s_add_u32 s56, s56, 110592
    buffer_load_dwordx4 v4, s[32:35], s56 offen nt lds
    s_add_u32 m0, m0, 4352
    s_add_u32 s56, s56, 110592
    buffer_load_dwordx4 v4, s[32:35], s56 offen nt lds
    s_add_u32 m0, m0, 4352
    s_add_u32 s56, s56, 110592
    buffer_load_dwordx4 v4, s[32:35], s56 offen nt lds
    v_bfe_u32 v44, v1, 2, 1
    v_lshlrev_b32 v44, 4, v44
    v_mov_b32 v45, 0x3f80
    v_lshlrev_b32 v44, v44, v45
    s_mov_b32 vcc_lo, 0x110011
    s_mov_b32 vcc_hi, vcc_lo
    v_cndmask_b32 v56, 0, v44, vcc
    s_mov_b32 vcc_lo, 0x220022
    s_mov_b32 vcc_hi, vcc_lo
    v_cndmask_b32 v57, 0, v44, vcc
    s_mov_b32 vcc_lo, 0x440044
    s_mov_b32 vcc_hi, vcc_lo
    v_cndmask_b32 v58, 0, v44, vcc
    s_mov_b32 vcc_lo, 0x880088
    s_mov_b32 vcc_hi, vcc_lo
    v_cndmask_b32 v59, 0, v44, vcc
    s_mov_b32 vcc_lo, 0x11001100
    s_mov_b32 vcc_hi, vcc_lo
    v_cndmask_b32 v60, 0, v44, vcc
    s_mov_b32 vcc_lo, 0x22002200
    s_mov_b32 vcc_hi, vcc_lo
    v_cndmask_b32 v61, 0, v44, vcc
    s_mov_b32 vcc_lo, 0x44004400
    s_mov_b32 vcc_hi, vcc_lo
    v_cndmask_b32 v62, 0, v44, vcc
    s_mov_b32 vcc_lo, 0x88008800
    s_mov_b32 vcc_hi, vcc_lo
    v_cndmask_b32 v63, 0, v44, vcc
    v_lshrrev_b32 v5, 1, v10
    v_xor_b32 v5, s45, v5
    v_lshlrev_b32 v5, 5, v5
    v_lshl_add_u32 v5, v10, 7, v5
    v_lshl_add_u32 v5, v9, 3, v5
    s_movk_i32 s54, 1088
    v_mad_u32_u24 v5, v2, s54, v5
    v_add_u32 v5, 16384, v5
    v_add_u32 v6, 43520, v5
    s_lshl_b32 s54, s45, 11
    s_add_u32 s54, s54, 3407872
    s_add_u32 s55, s54, 8192
    s_lshr_b32 s56, s45, 1
    s_lshl_b32 s56, s56, 11
    s_and_b32 s57, s45, 1
    s_lshl_b32 s57, s57, 7
    s_add_u32 s56, s56, s57
    s_add_u32 s56, s56, 3424256
    s_add_u32 s90, s54, 32768
    s_add_u32 s91, s55, 32768
    s_add_u32 s92, s56, 32768
    v_and_b32 v8, 1, v2
    v_mul_u32_u24 v8, 1408, v8
    v_lshl_add_u32 v8, v1, 3, v8
    s_lshl_b32 s57, s45, 6
    v_add_u32 v8, s57, v8
    v_lshrrev_b32 v11, 1, v2
    v_lshl_add_u32 v7, v11, 9, v8
    v_add_u32 v7, s57, v7
    s_mov_b32 vcc_lo, 0x00ff00ff
    s_mov_b32 vcc_hi, 0
    v_mov_b32 v44, 7168
    v_cndmask_b32 v8, v44, v8, vcc
    v_lshlrev_b32 v13, 5, v11
    v_lshl_add_u32 v13, v1, 1, v13
    v_lshrrev_b32 v14, 2, v13
    v_and_b32 v15, 1, v1
    v_lshl_add_u32 v14, v15, 4, v14
    v_lshrrev_b32_e64 v14, v14, s44
    v_lshlrev_b32 v14, 16, v14
    s_lshl_b32 s58, s61, 8
    s_add_u32 s58, s58, s57
    s_add_u32 s58, s58, 196608
    s_add_u32 s59, s58, 524288
    v_lshrrev_b32 v11, 3, v1
    v_xor_b32 v11, v11, v1
    v_and_b32 v11, 1, v11
    v_mul_u32_u24 v11, 1408, v11
    v_bfe_u32 v12, v1, 1, 1
    v_lshl_add_u32 v11, v12, 6, v11
    v_lshl_add_u32 v11, v2, 4, v11
    v_lshlrev_b32 v12, 5, v0
    v_and_b32 v16, 1, v2
    v_lshlrev_b32 v16, 10, v16
    v_lshrrev_b32 v15, 1, v2
    v_lshl_add_u32 v16, v15, 7, v16
    v_lshl_add_u32 v16, v1, 3, v16
    s_lshl_b32 s57, s45, 8
    v_add_u32 v30, s57, v16
    s_mov_b32 s57, 0x10000
    v_mov_b32 v32, 0x3f803f80
    v_mov_b32 v33, v32
    v_mov_b32 v34, v32
    v_mov_b32 v35, v32
    v_mov_b32 v68, 0
    v_mov_b32 v69, 0
    v_mov_b32 v70, 0
    v_mov_b32 v71, 0
    s_waitcnt vmcnt(0)
    s_barrier
    ds_read_b64_tr_b16 a[0:1], v5 offset:0
    ds_read_b64_tr_b16 a[2:3], v5 offset:512
    ds_read_b64_tr_b16 a[4:5], v5 offset:4352
    ds_read_b64_tr_b16 a[6:7], v5 offset:4864
    ds_read_b64_tr_b16 a[8:9], v5 offset:8704
    ds_read_b64_tr_b16 a[10:11], v5 offset:9216
    ds_read_b64_tr_b16 a[12:13], v5 offset:13056
    ds_read_b64_tr_b16 a[14:15], v5 offset:13568
    ds_read_b64_tr_b16 a[16:17], v5 offset:17408
    ds_read_b64_tr_b16 a[18:19], v5 offset:17920
    ds_read_b64_tr_b16 a[20:21], v5 offset:21760
    ds_read_b64_tr_b16 a[22:23], v5 offset:22272
    ds_read_b64_tr_b16 a[24:25], v5 offset:26112
    ds_read_b64_tr_b16 a[26:27], v5 offset:26624
    ds_read_b64_tr_b16 a[28:29], v5 offset:30464
    ds_read_b64_tr_b16 a[30:31], v5 offset:30976
    ds_read_b64_tr_b16 a[32:33], v5 offset:34816
    ds_read_b64_tr_b16 a[34:35], v5 offset:35328
    ds_read_b64_tr_b16 a[36:37], v5 offset:39168
    ds_read_b64_tr_b16 a[38:39], v5 offset:39680
    ds_read_b64_tr_b16 a[40:41], v6 offset:0
    ds_read_b64_tr_b16 a[42:43], v6 offset:512
    ds_read_b64_tr_b16 a[44:45], v6 offset:4352
    ds_read_b64_tr_b16 a[46:47], v6 offset:4864
    ds_read_b64_tr_b16 a[48:49], v6 offset:8704
    ds_read_b64_tr_b16 a[50:51], v6 offset:9216
    ds_read_b64_tr_b16 a[52:53], v6 offset:13056
    ds_read_b64_tr_b16 a[54:55], v6 offset:13568
    ds_read_b64_tr_b16 a[56:57], v6 offset:17408
    ds_read_b64_tr_b16 a[58:59], v6 offset:17920
    ds_read_b64_tr_b16 a[60:61], v6 offset:21760
    ds_read_b64_tr_b16 a[62:63], v6 offset:22272
    ds_read_b64_tr_b16 a[64:65], v6 offset:26112
    ds_read_b64_tr_b16 a[66:67], v6 offset:26624
    ds_read_b64_tr_b16 a[68:69], v6 offset:30464
    ds_read_b64_tr_b16 a[70:71], v6 offset:30976
    ds_read_b64_tr_b16 a[72:73], v6 offset:34816
    ds_read_b64_tr_b16 a[74:75], v6 offset:35328
    ds_read_b64_tr_b16 a[76:77], v6 offset:39168
    ds_read_b64_tr_b16 a[78:79], v6 offset:39680
    s_waitcnt lgkmcnt(0)
    v_mfma_f32_16x16x32_bf16 v[36:39], v[32:35], a[0:3], 0
    v_mfma_f32_16x16x32_bf16 v[36:39], v[32:35], a[4:7], v[36:39]
    v_mfma_f32_16x16x32_bf16 v[36:39], v[32:35], a[8:11], v[36:39]
    v_mfma_f32_16x16x32_bf16 v[36:39], v[32:35], a[12:15], v[36:39]
    v_mfma_f32_16x16x32_bf16 v[36:39], v[32:35], a[16:19], v[36:39]
    v_mfma_f32_16x16x32_bf16 v[36:39], v[32:35], a[20:23], v[36:39]
    v_mfma_f32_16x16x32_bf16 v[36:39], v[32:35], a[24:27], v[36:39]
    v_mfma_f32_16x16x32_bf16 v[36:39], v[32:35], a[28:31], v[36:39]
    v_mfma_f32_16x16x32_bf16 v[36:39], v[32:35], a[32:35], v[36:39]
    v_mfma_f32_16x16x32_bf16 v[36:39], v[32:35], a[36:39], v[36:39]
    v_mfma_f32_16x16x32_bf16 v[36:39], v[32:35], a[40:43], v[36:39]
    v_mfma_f32_16x16x32_bf16 v[36:39], v[32:35], a[44:47], v[36:39]
    v_mfma_f32_16x16x32_bf16 v[36:39], v[32:35], a[48:51], v[36:39]
    v_mfma_f32_16x16x32_bf16 v[36:39], v[32:35], a[52:55], v[36:39]
    v_mfma_f32_16x16x32_bf16 v[36:39], v[32:35], a[56:59], v[36:39]
    v_mfma_f32_16x16x32_bf16 v[36:39], v[32:35], a[60:63], v[36:39]
    v_mfma_f32_16x16x32_bf16 v[36:39], v[32:35], a[64:67], v[36:39]
    v_mfma_f32_16x16x32_bf16 v[36:39], v[32:35], a[68:71], v[36:39]
    v_mfma_f32_16x16x32_bf16 v[36:39], v[32:35], a[72:75], v[36:39]
    v_mfma_f32_16x16x32_bf16 v[36:39], v[32:35], a[76:79], v[36:39]
    s_cmp_lg_u32 s45, 3
    s_cbranch_scc1 L_gF_end
    v_lshlrev_b32 v40, 2, v1
    v_min_u32 v41, 9, v1
    v_lshlrev_b32 v41, 2, v41
    v_and_b32 v43, 7, v0
    v_lshlrev_b32 v43, 7, v43
    s_lshl_b32 s62, s46, 7
    s_add_u32 s62, s62, 991232
    s_mov_b32 s50, 0
L_gFa:
    buffer_load_dword v42, v41, s[28:31], s62 offen sc1
    s_add_u32 s50, s50, 1
    s_cmp_gt_u32 s50, 256
    s_cbranch_scc1 L_gFa_go
L_gFa_chk:
    s_waitcnt vmcnt(0)
    v_bitop3_b32 v42, v42, v42, s44 bitop3:0x7e
    v_cmp_ne_u32 vcc, 0, v42
    s_cbranch_vccnz L_gFa
L_gFa_go:
L_gF_end:
    s_barrier
    s_mov_b32 s50, 0
L_pollF:
    buffer_load_dwordx4 v[136:139], v31, s[28:31], s56 offen offset:0 sc1
    buffer_load_dwordx4 v[120:123], v3, s[28:31], s54 offen offset:0 sc1
    buffer_load_dwordx4 v[124:127], v3, s[28:31], s54 offen offset:1024 sc1
    buffer_load_dwordx4 v[128:131], v3, s[28:31], s55 offen offset:0 sc1
    buffer_load_dwordx4 v[132:135], v3, s[28:31], s55 offen offset:1024 sc1
    s_add_u32 s50, s50, 1
    s_cmp_gt_u32 s50, 40000
    s_cbranch_scc1 L_fail
L_pollF_chk:
    s_waitcnt vmcnt(4)
    v_xor_b32 v136, v136, v112
    v_xor_b32 v137, v137, v113
    v_xor_b32 v138, v138, v114
    v_xor_b32 v139, v139, v115
    v_bitop3_b32 v44, v136, v137, s48 bitop3:0x80
    v_bitop3_b32 v44, v44, v138, v139 bitop3:0x80
    v_mfma_f32_16x16x32_bf16 v[88:91], v[56:59], v[136:139], 0
    s_waitcnt vmcnt(3)
    v_xor_b32 v120, v120, v112
    v_xor_b32 v121, v121, v113
    v_xor_b32 v122, v122, v114
    v_xor_b32 v123, v123, v115
    v_bitop3_b32 v44, v120, v121, v44 bitop3:0x80
    v_bitop3_b32 v44, v44, v122, v123 bitop3:0x80
    v_mfma_f32_16x16x32_bf16 v[64:67], v[56:59], v[120:123], 0
    s_waitcnt vmcnt(2)
    v_xor_b32 v124, v124, v112
    v_xor_b32 v125, v125, v113
    v_xor_b32 v126, v126, v114
    v_xor_b32 v127, v127, v115
    v_bitop3_b32 v44, v124, v125, v44 bitop3:0x80
    v_bitop3_b32 v44, v44, v126, v127 bitop3:0x80
    v_mfma_f32_16x16x32_bf16 v[64:67], v[56:59], v[124:127], v[64:67]
    s_waitcnt vmcnt(1)
    v_xor_b32 v128, v128, v112
    v_xor_b32 v129, v129, v113
    v_xor_b32 v130, v130, v114
    v_xor_b32 v131, v131, v115
    v_bitop3_b32 v44, v128, v129, v44 bitop3:0x80
    v_bitop3_b32 v44, v44, v130, v131 bitop3:0x80
    v_mfma_f32_16x16x32_bf16 v[64:67], v[60:63], v[128:131], v[64:67]
    s_waitcnt vmcnt(0)
    v_xor_b32 v132, v132, v112
    v_xor_b32 v133, v133, v113
    v_xor_b32 v134, v134, v114
    v_xor_b32 v135, v135, v115
    v_bitop3_b32 v44, v132, v133, v44 bitop3:0x80
    v_bitop3_b32 v44, v44, v134, v135 bitop3:0x80
    v_mfma_f32_16x16x32_bf16 v[64:67], v[60:63], v[132:135], v[64:67]
    v_cmp_ne_u32 vcc, s48, v44
    s_cbranch_vccnz L_pollF
L_pollF_ok:
    v_add_f32_dpp v68, v88, v88 row_ror:8 row_mask:0xf bank_mask:0x3
    v_add_f32_dpp v69, v89, v89 row_ror:8 row_mask:0xf bank_mask:0x3
    v_add_f32_dpp v70, v90, v90 row_ror:8 row_mask:0xf bank_mask:0x3
    v_add_f32_dpp v71, v91, v91 row_ror:8 row_mask:0xf bank_mask:0x3
    v_cvt_pk_bf16_f32 v46, v68, v69
    v_cvt_pk_bf16_f32 v47, v70, v71
    v_cvt_pk_bf16_f32 v44, v64, v65
    v_cvt_pk_bf16_f32 v45, v66, v67
    ds_write_b64 v8, v[46:47] offset:1024
    ds_write_b64 v7, v[44:45] offset:0
    v_pk_add_f32 v[40:41], v[68:69], v[70:71]
    v_pk_mul_f32 v[42:43], v[68:69], v[68:69]
    v_pk_add_f32 v[40:41], v[40:41], v[64:65]
    v_pk_fma_f32 v[42:43], v[70:71], v[70:71], v[42:43]
    v_pk_add_f32 v[40:41], v[40:41], v[66:67]
    v_pk_fma_f32 v[42:43], v[64:65], v[64:65], v[42:43]
    v_add_f32 v40, v40, v41
    v_pk_fma_f32 v[42:43], v[66:67], v[66:67], v[42:43]
    v_add_f32 v41, v42, v43
    ds_write_b64 v30, v[40:41] offset:5120
    s_waitcnt lgkmcnt(0)
    s_barrier
    ds_read_b128 v[72:75], v11 offset:0
    ds_read_b128 v[76:79], v11 offset:128
    ds_read_b128 v[20:23], v12 offset:5120
    ds_read_b128 v[24:27], v12 offset:5136
    ds_read_b128 v[80:83], v11 offset:256
    ds_read_b128 v[84:87], v11 offset:384
    ds_read_b128 v[88:91], v11 offset:512
    ds_read_b128 v[92:95], v11 offset:640
    ds_read_b128 v[96:99], v11 offset:768
    ds_read_b128 v[100:103], v11 offset:896
    ds_read_b128 v[104:107], v11 offset:1024
    ds_read_b128 v[108:111], v11 offset:1152
    s_waitcnt lgkmcnt(11)
    v_mfma_f32_16x16x32_bf16 v[64:67], v[72:75], a[0:3], 0
    v_mfma_f32_16x16x32_bf16 v[68:71], v[72:75], a[4:7], 0
    s_waitcnt lgkmcnt(10)
    v_mfma_f32_16x16x32_bf16 v[64:67], v[76:79], a[8:11], v[64:67]
    v_mfma_f32_16x16x32_bf16 v[68:71], v[76:79], a[12:15], v[68:71]
    s_waitcnt lgkmcnt(7)
    v_mfma_f32_16x16x32_bf16 v[64:67], v[80:83], a[16:19], v[64:67]
    v_add_f32 v20, v20, v22
    v_add_f32 v21, v21, v23
    v_mfma_f32_16x16x32_bf16 v[68:71], v[80:83], a[20:23], v[68:71]
    v_add_f32 v24, v24, v26
    v_add_f32 v25, v25, v27
    s_waitcnt lgkmcnt(6)
    v_mfma_f32_16x16x32_bf16 v[64:67], v[84:87], a[24:27], v[64:67]
    v_add_f32 v40, v20, v24
    v_add_f32 v42, v21, v25
    v_mfma_f32_16x16x32_bf16 v[68:71], v[84:87], a[28:31], v[68:71]
    v_add_f32_dpp v40, v40, v40 quad_perm:[1,0,3,2] row_mask:0xf bank_mask:0xf
    v_add_f32_dpp v42, v42, v42 quad_perm:[1,0,3,2] row_mask:0xf bank_mask:0xf
    s_waitcnt lgkmcnt(5)
    v_mfma_f32_16x16x32_bf16 v[64:67], v[88:91], a[32:35], v[64:67]
    v_add_f32_dpp v40, v40, v40 quad_perm:[2,3,0,1] row_mask:0xf bank_mask:0xf
    v_add_f32_dpp v42, v42, v42 quad_perm:[2,3,0,1] row_mask:0xf bank_mask:0xf
    v_mfma_f32_16x16x32_bf16 v[68:71], v[88:91], a[36:39], v[68:71]
    v_add_f32_dpp v40, v40, v40 row_half_mirror row_mask:0xf bank_mask:0xf
    v_add_f32_dpp v42, v42, v42 row_half_mirror row_mask:0xf bank_mask:0xf
    s_waitcnt lgkmcnt(4)
    v_mfma_f32_16x16x32_bf16 v[64:67], v[92:95], a[40:43], v[64:67]
    v_add_f32_dpp v40, v40, v40 row_mirror row_mask:0xf bank_mask:0xf
    v_add_f32_dpp v42, v42, v42 row_mirror row_mask:0xf bank_mask:0xf
    v_mfma_f32_16x16x32_bf16 v[68:71], v[92:95], a[44:47], v[68:71]
    v_mov_b32 v41, v40
    v_mov_b32 v43, v42
    s_waitcnt lgkmcnt(3)
    v_mfma_f32_16x16x32_bf16 v[64:67], v[96:99], a[48:51], v[64:67]
    v_permlane16_swap_b32 v40, v41
    v_mfma_f32_16x16x32_bf16 v[68:71], v[96:99], a[52:55], v[68:71]
    v_permlane16_swap_b32 v42, v43
    s_waitcnt lgkmcnt(2)
    v_mfma_f32_16x16x32_bf16 v[64:67], v[100:103], a[56:59], v[64:67]
    v_add_f32 v40, v40, v41
    v_add_f32 v42, v42, v43
    v_mfma_f32_16x16x32_bf16 v[68:71], v[100:103], a[60:63], v[68:71]
    v_mul_f32 v40, 0x3acccccd, v40
    v_mul_f32 v42, 0x3acccccd, v42
    s_waitcnt lgkmcnt(1)
    v_mfma_f32_16x16x32_bf16 v[64:67], v[104:107], a[64:67], v[64:67]
    v_fma_f32 v42, -v40, v40, v42
    v_max_f32 v42, 0, v42
    v_mfma_f32_16x16x32_bf16 v[68:71], v[104:107], a[68:71], v[68:71]
    v_add_f32 v42, 0x3727c5ac, v42
    v_mul_f32 v40, v40, v36
    s_waitcnt lgkmcnt(0)
    v_mfma_f32_16x16x32_bf16 v[64:67], v[108:111], a[72:75], v[64:67]
    v_rsq_f32 v42, v42
    v_mfma_f32_16x16x32_bf16 v[68:71], v[108:111], a[76:79], v[68:71]
    v_mul_f32 v43, 0xbfb8aa3b, v42
    s_nop 2
    v_mov_b32 v250, v0
    s_nop 0
    v_sub_f32 v64, v64, v40
    s_nop 0
    v_add_f32 v64, v64, v70
    v_mul_f32 v65, v64, v43
    v_exp_f32 v65, v65
    v_mul_f32 v64, v64, v42
    v_add_f32 v65, 1.0, v65
    v_rcp_f32 v65, v65
    s_nop 0
    v_mul_f32 v64, v64, v65
    v_bfi_b32 v64, s57, v14, v64
    buffer_store_short_d16_hi v64, v13, s[28:31], s59 offen
    s_waitcnt vmcnt(0)
    s_barrier
    buffer_store_short_d16_hi v64, v13, s[28:31], s58 offen sc1
    s_or_b32 s61, s61, s45
    s_cbranch_scc1 L_done
    s_mov_b64 exec, 1
    v_mov_b32 v4, s44
    buffer_store_dword v4, v3, s[28:31], 0 offen sc1
    s_branch L_done
L_Y:
    s_add_u32 s51, s51, s52
    s_lshr_b32 s54, s47, 1
    s_lshl_b32 s54, s54, 3
    s_add_u32 s54, s54, s46
    s_and_b32 s55, s47, 1
    s_lshl_b32 s56, s54, 17
    s_lshl_b32 s57, s45, 15
    s_add_u32 s56, s56, s57
    s_mul_i32 s57, s45, 33792
    s_mov_b32 s34, 8388608
    s_mov_b32 s38, 4194304
    s_mov_b32 s42, 5242880
    s_mul_i32 s90, s55, 0
    s_lshl_b32 s91, s47, 18
    s_lshl_b32 s92, s45, 16
    s_add_u32 s91, s91, s92
    s_lshl_b32 s92, s46, 10
    s_add_u32 s91, s91, s92
    s_mul_i32 s93, s47, 327680
    s_add_u32 s92, s92, s93
    s_lshl_b32 s93, s45, 16
    s_add_u32 s92, s92, s93
    s_add_u32 s92, s92, 384
    v_lshrrev_b32 v4, 3, v0
    v_and_b32 v5, 7, v0
    v_lshlrev_b32 v5, 4, v5
    v_lshl_add_u32 v4, v4, 13, v5
    s_waitcnt lgkmcnt(0)
    s_mov_b64 s[40:41], s[8:9]
    s_mov_b64 s[36:37], s[10:11]
    s_mov_b64 s[32:33], s[6:7]
    s_load_dword s44, s[26:27], 0
    s_xor_b32 s93, s90, 0
    s_mul_i32 s92, s93, 4224
    s_add_u32 m0, s92, s57
    s_lshl_b32 s93, s93, 12
    s_add_u32 s93, s93, s56
    buffer_load_dwordx4 v3, s[32:35], s93 offen offset:0 nt lds
    s_add_u32 m0, m0, 32
    s_nop 0
    buffer_load_dwordx4 v3, s[32:35], s93 offen offset:1024 nt lds
    s_add_u32 m0, m0, 32
    s_nop 0
    buffer_load_dwordx4 v3, s[32:35], s93 offen offset:2048 nt lds
    s_add_u32 m0, m0, 32
    s_nop 0
    buffer_load_dwordx4 v3, s[32:35], s93 offen offset:3072 nt lds
    s_xor_b32 s93, s90, 1
    s_mul_i32 s92, s93, 4224
    s_add_u32 m0, s92, s57
    s_lshl_b32 s93, s93, 12
    s_add_u32 s93, s93, s56
    buffer_load_dwordx4 v3, s[32:35], s93 offen offset:0 nt lds
    s_add_u32 m0, m0, 32
    s_nop 0
    buffer_load_dwordx4 v3, s[32:35], s93 offen offset:1024 nt lds
    s_add_u32 m0, m0, 32
    s_nop 0
    buffer_load_dwordx4 v3, s[32:35], s93 offen offset:2048 nt lds
    s_add_u32 m0, m0, 32
    s_nop 0
    buffer_load_dwordx4 v3, s[32:35], s93 offen offset:3072 nt lds
    s_xor_b32 s93, s90, 2
    s_mul_i32 s92, s93, 4224
    s_add_u32 m0, s92, s57
    s_lshl_b32 s93, s93, 12
    s_add_u32 s93, s93, s56
    buffer_load_dwordx4 v3, s[32:35], s93 offen offset:0 nt lds
    s_add_u32 m0, m0, 32
    s_nop 0
    buffer_load_dwordx4 v3, s[32:35], s93 offen offset:1024 nt lds
    s_add_u32 m0, m0, 32
    s_nop 0
    buffer_load_dwordx4 v3, s[32:35], s93 offen offset:2048 nt lds
    s_add_u32 m0, m0, 32
    s_nop 0
    buffer_load_dwordx4 v3, s[32:35], s93 offen offset:3072 nt lds
    s_mov_b64 s[28:29], s[26:27]
    s_mov_b64 s[36:37], s[12:13]
    s_waitcnt lgkmcnt(0)
    s_not_b32 s44, s44
    v_and_b32 v4, 2, v2
    v_xor_b32 v4, v4, v9
    v_lshlrev_b32 v44, 2, v9
    v_lshrrev_b32_e64 v48, v44, s44
    v_lshrrev_b32 v49, 1, v48
    v_lshrrev_b32 v50, 2, v48
    v_lshrrev_b32 v51, 3, v48
    v_lshlrev_b32 v44, 2, v4
    v_lshrrev_b32_e64 v56, v44, s44
    s_xor_b32 s93, s90, 3
    s_mul_i32 s92, s93, 4224
    s_add_u32 m0, s92, s57
    s_lshl_b32 s93, s93, 12
    s_add_u32 s93, s93, s56
    buffer_load_dwordx4 v3, s[32:35], s93 offen offset:0 nt lds
    v_lshrrev_b32 v57, 1, v56
    v_lshrrev_b32 v58, 2, v56
    v_lshrrev_b32 v59, 3, v56
    v_bitop3_b32 v56, v56, v56, s48 bitop3:0x0a
    v_bitop3_b32 v57, v57, v57, s48 bitop3:0x0a
    v_bitop3_b32 v58, v58, v58, s48 bitop3:0x0a
    v_bitop3_b32 v59, v59, v59, s48 bitop3:0x0a
    v_bitop3_b32 v60, v48, v48, s48 bitop3:0x0a
    v_bitop3_b32 v61, v49, v49, s48 bitop3:0x0a
    v_bitop3_b32 v62, v50, v50, s48 bitop3:0x0a
    v_bitop3_b32 v63, v51, v51, s48 bitop3:0x0a
    v_and_b32 v44, 7, v0
    v_lshlrev_b32 v44, 1, v44
    s_add_u32 m0, m0, 32
    s_nop 0
    buffer_load_dwordx4 v3, s[32:35], s93 offen offset:1024 nt lds
    v_lshrrev_b32_e64 v48, v44, s44
    v_lshrrev_b32 v49, 1, v48
    v_mov_b32 v50, v48
    v_mov_b32 v51, v49
    v_lshrrev_b32_e64 v52, v1, s44
    v_and_b32 v5, 60, v0
    v_add_u32 v4, v4, v5
    v_lshlrev_b32 v4, 4, v4
    s_lshr_b32 s58, s54, 5
    s_lshl_b32 s58, s58, 15
    s_lshl_b32 s59, s55, 10
    s_add_u32 s58, s58, s59
    s_lshl_b32 s59, s45, 13
    s_add_u32 m0, m0, 32
    s_nop 0
    buffer_load_dwordx4 v3, s[32:35], s93 offen offset:2048 nt lds
    s_add_u32 s58, s58, s59
    s_add_u32 s58, s58, 3145728
    s_add_u32 s59, s58, 4096
    s_add_u32 s18, s58, 65536
    s_add_u32 s19, s59, 65536
    s_lshl_b32 s60, s45, 12
    s_add_u32 s60, s60, 135168
    v_add_u32 v5, s60, v3
    v_lshrrev_b32 v6, 2, v1
    v_and_b32 v6, 2, v6
    v_xor_b32 v6, v6, v2
    v_lshlrev_b32 v6, 4, v6
    v_lshl_add_u32 v6, v1, 6, v6
    s_add_u32 m0, m0, 32
    s_nop 0
    buffer_load_dwordx4 v3, s[32:35], s93 offen offset:3072 nt lds
    v_add_u32 v6, 135168, v6
    s_xor_b32 s60, s45, 0
    s_lshl_b32 s60, s60, 12
    v_add_u32 v104, s60, v6
    s_xor_b32 s60, s45, 1
    s_lshl_b32 s60, s60, 12
    v_add_u32 v105, s60, v6
    s_xor_b32 s60, s45, 2
    s_lshl_b32 s60, s60, 12
    v_add_u32 v106, s60, v6
    s_xor_b32 s60, s45, 3
    s_lshl_b32 s60, s60, 12
    v_add_u32 v107, s60, v6
    s_xor_b32 s93, s90, 4
    s_mul_i32 s92, s93, 4224
    s_add_u32 m0, s92, s57
    s_lshl_b32 s93, s93, 12
    s_add_u32 s93, s93, s56
    buffer_load_dwordx4 v3, s[32:35], s93 offen offset:0 nt lds
    v_mul_u32_u24 v7, 1056, v1
    v_lshl_add_u32 v7, v2, 4, v7
    v_add_u32 v7, s57, v7
    s_xor_b32 s60, s45, 0
    s_lshl_b32 s60, s60, 8
    v_add_u32 v108, s60, v7
    s_xor_b32 s60, s45, 1
    s_lshl_b32 s60, s60, 8
    v_add_u32 v109, s60, v7
    s_xor_b32 s60, s45, 2
    s_lshl_b32 s60, s60, 8
    v_add_u32 v110, s60, v7
    s_xor_b32 s60, s45, 3
    s_add_u32 m0, m0, 32
    s_nop 0
    buffer_load_dwordx4 v3, s[32:35], s93 offen offset:1024 nt lds
    s_lshl_b32 s60, s60, 8
    v_add_u32 v111, s60, v7
    v_lshrrev_b32 v8, 2, v0
    v_mul_u32_u24 v8, 1056, v8
    v_lshl_add_u32 v8, v9, 3, v8
    s_lshl_b32 s60, s45, 8
    v_add_u32 v8, s60, v8
    v_add_u32 v11, 67584, v8
    s_lshl_b32 s60, s45, 2
    s_lshl_b32 s49, 15, s60
    s_add_u32 s60, s60, 158720
    v_add_u32 v12, s60, v3
    v_lshlrev_b32 v13, 2, v1
    s_add_u32 m0, m0, 32
    s_nop 0
    buffer_load_dwordx4 v3, s[32:35], s93 offen offset:2048 nt lds
    v_add_u32 v13, 155648, v13
    v_mov_b32 v33, s44
    v_mov_b32 v35, s44
    v_add_u32 v15, 151552, v3
    s_lshl_b32 s60, s45, 10
    v_add_u32 v14, s60, v15
    v_lshlrev_b32 v16, 18, v2
    v_lshl_add_u32 v16, v1, 3, v16
    s_lshl_b32 s60, s55, 20
    s_lshl_b32 s61, s45, 14
    s_add_u32 s60, s60, s61
    s_lshl_b32 s61, s54, 8
    s_add_u32 s60, s60, s61
    s_add_u32 m0, m0, 32
    s_nop 0
    buffer_load_dwordx4 v3, s[32:35], s93 offen offset:3072 nt lds
    s_add_u32 s4, s60, 1048576
    s_add_u32 s5, s4, 0x10000
    s_add_u32 s6, s4, 0x20000
    s_add_u32 s7, s4, 0x30000
    v_lshlrev_b32 v17, 10, v1
    s_mov_b32 vcc_lo, s49
    s_mov_b32 vcc_hi, 0
    v_mov_b32 v44, 1073741824
    v_cndmask_b32 v17, v44, v17, vcc
    s_lshl_b32 s61, s55, 14
    s_lshl_b32 s62, s54, 4
    s_add_u32 s61, s61, s62
    s_add_u32 s61, s61, 262144
    s_xor_b32 s93, s90, 5
    s_mul_i32 s92, s93, 4224
    s_add_u32 m0, s92, s57
    s_lshl_b32 s93, s93, 12
    s_add_u32 s93, s93, s56
    buffer_load_dwordx4 v3, s[32:35], s93 offen offset:0 nt lds
    v_lshlrev_b32 v18, 13, v2
    v_lshl_add_u32 v18, v1, 4, v18
    s_lshl_b32 s62, s53, 20
    s_lshl_b32 s63, s45, 18
    s_add_u32 s62, s62, s63
    s_lshl_b32 s63, s51, 8
    s_add_u32 s62, s62, s63
    v_lshlrev_b32 v53, 2, v1
    s_lshl_b32 s8, s46, 7
    s_add_u32 s8, s8, 983040
    s_lshl_b32 s49, s47, 2
    s_add_u32 s8, s8, s49
    s_lshl_b32 s16, s46, 7
    s_add_u32 m0, m0, 32
    s_nop 0
    buffer_load_dwordx4 v3, s[32:35], s93 offen offset:1024 nt lds
    s_add_u32 s16, s16, 987136
    s_cmp_eq_u32 s45, 0
    s_cselect_b32 s49, 1, 0
    v_mov_b32 v19, 0
    s_mov_b32 vcc_lo, s49
    s_mov_b32 vcc_hi, 0
    v_mov_b32 v44, 1073741824
    v_cndmask_b32 v19, v44, v19, vcc
    s_lshl_b32 s17, s55, 9
    s_add_u32 s17, s17, 1015808
    v_lshlrev_b32 v249, 7, v9
    s_add_u32 s20, s8, 0x4000
    v_mul_u32_u24 v44, 2432, v2
    s_add_u32 m0, m0, 32
    s_nop 0
    buffer_load_dwordx4 v3, s[32:35], s93 offen offset:2048 nt lds
    s_mul_i32 s54, s45, 576
    v_lshl_add_u32 v40, v1, 4, v44
    v_add_u32 v40, s54, v40
    s_lshl_b32 s54, s45, 6
    v_mul_u32_u24 v41, 288, v10
    v_lshlrev_b32 v44, 1, v44
    v_add3_u32 v41, v41, v44, s54
    v_lshl_add_u32 v41, v9, 3, v41
    s_lshl_b32 s9, s51, 10
    s_add_u32 s9, s9, 262144
    s_lshl_b32 s55, s51, 2
    s_add_u32 s55, s55, s53
    s_lshl_b32 s10, s55, 14
    s_add_u32 m0, m0, 32
    s_nop 0
    buffer_load_dwordx4 v3, s[32:35], s93 offen offset:3072 nt lds
    s_lshl_b32 s11, s45, 11
    s_add_u32 s10, s10, s11
    s_add_u32 s10, s10, 1048576
    s_add_u32 s11, s10, 8192
    s_lshl_b32 s14, s55, 9
    s_lshl_b32 s15, s45, 7
    s_add_u32 s14, s14, s15
    s_add_u32 s14, s14, 327680
    s_add_u32 s15, s14, 524288
    v_lshlrev_b32 v42, 2, v0
    v_lshrrev_b32 v43, 3, v1
    v_lshl_add_u32 v43, v43, 5, v2
    s_lshl_b32 s54, s45, 3
    s_xor_b32 s93, s90, 6
    s_mul_i32 s92, s93, 4224
    s_add_u32 m0, s92, s57
    s_lshl_b32 s93, s93, 12
    s_add_u32 s93, s93, s56
    buffer_load_dwordx4 v3, s[32:35], s93 offen offset:0 nt lds
    v_add_lshl_u32 v43, v43, s54, 2
    v_lshrrev_b32 v46, 1, v2
    v_mul_u32_u24 v46, 288, v46
    v_lshl_add_u32 v46, v1, 4, v46
    v_and_b32 v47, 1, v2
    v_lshl_add_u32 v46, v47, 3, v46
    s_mul_i32 s54, s45, 576
    s_add_u32 s54, s54, 155904
    v_add_u32 v46, s54, v46
    v_and_b32 v47, 7, v1
    v_mul_u32_u24 v47, 288, v47
    v_lshl_add_u32 v47, v2, 4, v47
    v_add_u32 v47, 155904, v47
    s_add_u32 m0, m0, 32
    s_nop 0
    buffer_load_dwordx4 v3, s[32:35], s93 offen offset:1024 nt lds
    v_and_b32 v44, 1, v1
    v_lshlrev_b32 v44, 4, v44
    v_mov_b32 v45, 0xffff
    v_lshlrev_b32 v45, v44, v45
    s_mov_b32 vcc_lo, 0x30003
    s_mov_b32 vcc_hi, vcc_lo
    v_cndmask_b32 v224, 0, v45, vcc
    s_mov_b32 vcc_lo, 0xc000c
    s_mov_b32 vcc_hi, vcc_lo
    v_cndmask_b32 v225, 0, v45, vcc
    s_mov_b32 vcc_lo, 0x300030
    s_mov_b32 vcc_hi, vcc_lo
    v_cndmask_b32 v226, 0, v45, vcc
    s_add_u32 m0, m0, 32
    s_nop 0
    buffer_load_dwordx4 v3, s[32:35], s93 offen offset:2048 nt lds
    s_mov_b32 vcc_lo, 0xc000c0
    s_mov_b32 vcc_hi, vcc_lo
    v_cndmask_b32 v227, 0, v45, vcc
    s_mov_b32 vcc_lo, 0x3000300
    s_mov_b32 vcc_hi, vcc_lo
    v_cndmask_b32 v228, 0, v45, vcc
    s_mov_b32 vcc_lo, 0xc000c00
    s_mov_b32 vcc_hi, vcc_lo
    v_cndmask_b32 v229, 0, v45, vcc
    s_mov_b32 vcc_lo, 0x30003000
    s_mov_b32 vcc_hi, vcc_lo
    v_cndmask_b32 v230, 0, v45, vcc
    s_mov_b32 vcc_lo, 0xc000c000
    s_add_u32 m0, m0, 32
    s_nop 0
    buffer_load_dwordx4 v3, s[32:35], s93 offen offset:3072 nt lds
    s_mov_b32 vcc_hi, vcc_lo
    v_cndmask_b32 v231, 0, v45, vcc
    s_mov_b32 vcc_lo, -1
    s_mov_b32 vcc_hi, 0
    v_mov_b32 v44, 1073741824
    v_cndmask_b32 v42, v44, v42, vcc
    s_xor_b32 s93, s90, 7
    s_mul_i32 s92, s93, 4224
    s_add_u32 m0, s92, s57
    s_lshl_b32 s93, s93, 12
    s_add_u32 s93, s93, s56
    buffer_load_dwordx4 v3, s[32:35], s93 offen offset:0 nt lds
    s_add_u32 m0, m0, 32
    s_nop 0
    buffer_load_dwordx4 v3, s[32:35], s93 offen offset:1024 nt lds
    s_add_u32 m0, m0, 32
    s_nop 0
    buffer_load_dwordx4 v3, s[32:35], s93 offen offset:2048 nt lds
    s_add_u32 m0, m0, 32
    s_nop 0
    buffer_load_dwordx4 v3, s[32:35], s93 offen offset:3072 nt lds
    v_mov_b32 v44, 0xff800000
    ds_write_b32 v13, v44
    s_waitcnt vmcnt(16)
    s_barrier
    ds_read_b128 a[0:3], v108 offset:0
    ds_read_b128 a[4:7], v108 offset:64
    ds_read_b128 a[8:11], v108 offset:128
    ds_read_b128 a[12:15], v108 offset:192
    ds_read_b128 a[16:19], v109 offset:0
    ds_read_b128 a[20:23], v109 offset:64
    ds_read_b128 a[24:27], v109 offset:128
    ds_read_b128 a[28:31], v109 offset:192
    ds_read_b128 a[32:35], v110 offset:0
    ds_read_b128 a[36:39], v110 offset:64
    ds_read_b128 a[40:43], v110 offset:128
    ds_read_b128 a[44:47], v110 offset:192
    ds_read_b128 a[48:51], v111 offset:0
    ds_read_b128 a[52:55], v111 offset:64
    ds_read_b128 a[56:59], v111 offset:128
    ds_read_b128 a[60:63], v111 offset:192
    ds_read_b64_tr_b16 a[128:129], v8 offset:0
    ds_read_b64_tr_b16 a[144:145], v8 offset:32
    ds_read_b64_tr_b16 a[160:161], v8 offset:64
    ds_read_b64_tr_b16 a[176:177], v8 offset:96
    ds_read_b64_tr_b16 a[192:193], v8 offset:128
    ds_read_b64_tr_b16 a[208:209], v8 offset:160
    ds_read_b64_tr_b16 a[224:225], v8 offset:192
    ds_read_b64_tr_b16 a[240:241], v8 offset:224
    ds_read_b64_tr_b16 a[132:133], v8 offset:33792
    ds_read_b64_tr_b16 a[148:149], v8 offset:33824
    ds_read_b64_tr_b16 a[164:165], v8 offset:33856
    ds_read_b64_tr_b16 a[180:181], v8 offset:33888
    ds_read_b64_tr_b16 a[196:197], v8 offset:33920
    ds_read_b64_tr_b16 a[212:213], v8 offset:33952
    ds_read_b64_tr_b16 a[228:229], v8 offset:33984
    ds_read_b64_tr_b16 a[244:245], v8 offset:34016
    ds_read_b64_tr_b16 a[136:137], v11 offset:0
    ds_read_b64_tr_b16 a[152:153], v11 offset:32
    ds_read_b64_tr_b16 a[168:169], v11 offset:64
    ds_read_b64_tr_b16 a[184:185], v11 offset:96
    ds_read_b64_tr_b16 a[200:201], v11 offset:128
    ds_read_b64_tr_b16 a[216:217], v11 offset:160
    ds_read_b64_tr_b16 a[232:233], v11 offset:192
    ds_read_b64_tr_b16 a[248:249], v11 offset:224
    ds_read_b64_tr_b16 a[140:141], v11 offset:33792
    ds_read_b64_tr_b16 a[156:157], v11 offset:33824
    ds_read_b64_tr_b16 a[172:173], v11 offset:33856
    ds_read_b64_tr_b16 a[188:189], v11 offset:33888
    ds_read_b64_tr_b16 a[204:205], v11 offset:33920
    ds_read_b64_tr_b16 a[220:221], v11 offset:33952
    ds_read_b64_tr_b16 a[236:237], v11 offset:33984
    ds_read_b64_tr_b16 a[252:253], v11 offset:34016
    buffer_load_dword v248, v17, s[28:31], s61 offen sc1
    buffer_load_dwordx4 v[192:195], v18, s[36:39], s62 offen nt
    s_add_u32 s62, s62, 32768
    buffer_load_dwordx4 v[196:199], v18, s[36:39], s62 offen nt
    s_add_u32 s62, s62, 32768
    buffer_load_dwordx4 v[200:203], v18, s[36:39], s62 offen nt
    s_add_u32 s62, s62, 32768
    buffer_load_dwordx4 v[204:207], v18, s[36:39], s62 offen nt
    s_add_u32 s62, s62, 32768
    s_waitcnt vmcnt(4)
    buffer_load_dword v54, v53, s[28:31], s16 offen sc1
    s_waitcnt vmcnt(5)
    s_cmp_lg_u32 s45, 3
    s_cbranch_scc1 L_qh_go
    s_mov_b32 s50, 0
    s_branch L_qh_chk
L_qh:
    buffer_load_dword v54, v53, s[28:31], s16 offen sc1
    s_add_u32 s50, s50, 1
    s_cmp_gt_u32 s50, 64
    s_cbranch_scc1 L_qh_go
L_qh_chk:
    s_waitcnt vmcnt(0)
    v_bitop3_b32 v54, v54, v54, s44 bitop3:0x7e
    v_cmp_ne_u32 vcc, 0, v54
    s_cbranch_vccnz L_qh
L_qh_go:
    s_barrier
    buffer_load_dwordx4 v[64:67], v4, s[28:31], s58 offen offset:0 sc1
    buffer_load_dwordx4 v[68:71], v4, s[28:31], s58 offen offset:2048 sc1
    buffer_load_dwordx4 v[72:75], v4, s[28:31], s59 offen offset:0 sc1
    buffer_load_dwordx4 v[76:79], v4, s[28:31], s59 offen offset:2048 sc1
    ds_read_b128 a[64:67], v108 offset:16896
    ds_read_b128 a[68:71], v108 offset:16960
    ds_read_b128 a[72:75], v108 offset:17024
    ds_read_b128 a[76:79], v108 offset:17088
    ds_read_b128 a[80:83], v109 offset:16896
    ds_read_b128 a[84:87], v109 offset:16960
    ds_read_b128 a[88:91], v109 offset:17024
    ds_read_b128 a[92:95], v109 offset:17088
    ds_read_b128 a[96:99], v110 offset:16896
    ds_read_b128 a[100:103], v110 offset:16960
    ds_read_b128 a[104:107], v110 offset:17024
    ds_read_b128 a[108:111], v110 offset:17088
    ds_read_b128 a[112:115], v111 offset:16896
    ds_read_b128 a[116:119], v111 offset:16960
    ds_read_b128 a[120:123], v111 offset:17024
    ds_read_b128 a[124:127], v111 offset:17088
    ds_read_b64_tr_b16 a[130:131], v8 offset:16896
    ds_read_b64_tr_b16 a[146:147], v8 offset:16928
    ds_read_b64_tr_b16 a[162:163], v8 offset:16960
    ds_read_b64_tr_b16 a[178:179], v8 offset:16992
    ds_read_b64_tr_b16 a[194:195], v8 offset:17024
    ds_read_b64_tr_b16 a[210:211], v8 offset:17056
    ds_read_b64_tr_b16 a[226:227], v8 offset:17088
    ds_read_b64_tr_b16 a[242:243], v8 offset:17120
    ds_read_b64_tr_b16 a[134:135], v8 offset:50688
    ds_read_b64_tr_b16 a[150:151], v8 offset:50720
    ds_read_b64_tr_b16 a[166:167], v8 offset:50752
    ds_read_b64_tr_b16 a[182:183], v8 offset:50784
    ds_read_b64_tr_b16 a[198:199], v8 offset:50816
    ds_read_b64_tr_b16 a[214:215], v8 offset:50848
    ds_read_b64_tr_b16 a[230:231], v8 offset:50880
    ds_read_b64_tr_b16 a[246:247], v8 offset:50912
    buffer_load_dwordx4 v[232:235], v4, s[28:31], s18 offen offset:0 sc1
    buffer_load_dwordx4 v[236:239], v4, s[28:31], s18 offen offset:2048 sc1
    buffer_load_dwordx4 v[240:243], v4, s[28:31], s19 offen offset:0 sc1
    buffer_load_dwordx4 v[244:247], v4, s[28:31], s19 offen offset:2048 sc1
    ds_read_b64_tr_b16 a[138:139], v11 offset:16896
    ds_read_b64_tr_b16 a[154:155], v11 offset:16928
    ds_read_b64_tr_b16 a[170:171], v11 offset:16960
    ds_read_b64_tr_b16 a[186:187], v11 offset:16992
    ds_read_b64_tr_b16 a[202:203], v11 offset:17024
    ds_read_b64_tr_b16 a[218:219], v11 offset:17056
    ds_read_b64_tr_b16 a[234:235], v11 offset:17088
    ds_read_b64_tr_b16 a[250:251], v11 offset:17120
    ds_read_b64_tr_b16 a[142:143], v11 offset:50688
    ds_read_b64_tr_b16 a[158:159], v11 offset:50720
    ds_read_b64_tr_b16 a[174:175], v11 offset:50752
    ds_read_b64_tr_b16 a[190:191], v11 offset:50784
    ds_read_b64_tr_b16 a[206:207], v11 offset:50816
    ds_read_b64_tr_b16 a[222:223], v11 offset:50848
    ds_read_b64_tr_b16 a[238:239], v11 offset:50880
    ds_read_b64_tr_b16 a[254:255], v11 offset:50912
    s_mov_b32 s50, 0
L_pollC:
    s_waitcnt vmcnt(7)
    v_xor_b32 v64, v64, v56
    v_xor_b32 v65, v65, v57
    v_xor_b32 v66, v66, v58
    v_xor_b32 v67, v67, v59
    v_bitop3_b32 v44, v64, v65, s48 bitop3:0x80
    v_bitop3_b32 v44, v44, v66, v67 bitop3:0x80
    ds_write_b128 v5, v[64:67] offset:0
    s_waitcnt vmcnt(6)
    v_xor_b32 v68, v68, v56
    v_xor_b32 v69, v69, v57
    v_xor_b32 v70, v70, v58
    v_xor_b32 v71, v71, v59
    v_bitop3_b32 v44, v68, v69, v44 bitop3:0x80
    v_bitop3_b32 v44, v44, v70, v71 bitop3:0x80
    ds_write_b128 v5, v[68:71] offset:1024
    s_waitcnt vmcnt(5)
    v_xor_b32 v72, v72, v56
    v_xor_b32 v73, v73, v57
    v_xor_b32 v74, v74, v58
    v_xor_b32 v75, v75, v59
    v_bitop3_b32 v44, v72, v73, v44 bitop3:0x80
    v_bitop3_b32 v44, v44, v74, v75 bitop3:0x80
    ds_write_b128 v5, v[72:75] offset:2048
    s_waitcnt vmcnt(4)
    v_xor_b32 v76, v76, v56
    v_xor_b32 v77, v77, v57
    v_xor_b32 v78, v78, v58
    v_xor_b32 v79, v79, v59
    v_bitop3_b32 v44, v76, v77, v44 bitop3:0x80
    v_bitop3_b32 v44, v44, v78, v79 bitop3:0x80
    ds_write_b128 v5, v[76:79] offset:3072
    v_cmp_ne_u32 vcc, s48, v44
    s_cbranch_vccz L_pollC_ok
    s_xor_b32 s58, s58, 131072
    s_xor_b32 s59, s59, 131072
    buffer_load_dwordx4 v[64:67], v4, s[28:31], s58 offen offset:0 sc1
    buffer_load_dwordx4 v[68:71], v4, s[28:31], s58 offen offset:2048 sc1
    buffer_load_dwordx4 v[72:75], v4, s[28:31], s59 offen offset:0 sc1
    buffer_load_dwordx4 v[76:79], v4, s[28:31], s59 offen offset:2048 sc1
    s_waitcnt vmcnt(7)
    v_xor_b32 v232, v232, v56
    v_xor_b32 v233, v233, v57
    v_xor_b32 v234, v234, v58
    v_xor_b32 v235, v235, v59
    v_bitop3_b32 v44, v232, v233, s48 bitop3:0x80
    v_bitop3_b32 v44, v44, v234, v235 bitop3:0x80
    ds_write_b128 v5, v[232:235] offset:0
    s_waitcnt vmcnt(6)
    v_xor_b32 v236, v236, v56
    v_xor_b32 v237, v237, v57
    v_xor_b32 v238, v238, v58
    v_xor_b32 v239, v239, v59
    v_bitop3_b32 v44, v236, v237, v44 bitop3:0x80
    v_bitop3_b32 v44, v44, v238, v239 bitop3:0x80
    ds_write_b128 v5, v[236:239] offset:1024
    s_waitcnt vmcnt(5)
    v_xor_b32 v240, v240, v56
    v_xor_b32 v241, v241, v57
    v_xor_b32 v242, v242, v58
    v_xor_b32 v243, v243, v59
    v_bitop3_b32 v44, v240, v241, v44 bitop3:0x80
    v_bitop3_b32 v44, v44, v242, v243 bitop3:0x80
    ds_write_b128 v5, v[240:243] offset:2048
    s_waitcnt vmcnt(4)
    v_xor_b32 v244, v244, v56
    v_xor_b32 v245, v245, v57
    v_xor_b32 v246, v246, v58
    v_xor_b32 v247, v247, v59
    v_bitop3_b32 v44, v244, v245, v44 bitop3:0x80
    v_bitop3_b32 v44, v44, v246, v247 bitop3:0x80
    ds_write_b128 v5, v[244:247] offset:3072
    v_cmp_ne_u32 vcc, s48, v44
    s_cbranch_vccz L_pollC_ok
    s_xor_b32 s18, s18, 131072
    s_xor_b32 s19, s19, 131072
    buffer_load_dwordx4 v[232:235], v4, s[28:31], s18 offen offset:0 sc1
    buffer_load_dwordx4 v[236:239], v4, s[28:31], s18 offen offset:2048 sc1
    buffer_load_dwordx4 v[240:243], v4, s[28:31], s19 offen offset:0 sc1
    buffer_load_dwordx4 v[244:247], v4, s[28:31], s19 offen offset:2048 sc1
    s_add_u32 s50, s50, 1
    s_cmp_gt_u32 s50, 40000
    s_cbranch_scc0 L_pollC
    s_branch L_fail
L_pollC_ok:
    ds_read_b128 v[128:131], v104 offset:0
    ds_read_b128 v[132:135], v104 offset:1024
    ds_read_b128 v[136:139], v104 offset:2048
    ds_read_b128 v[140:143], v104 offset:3072
    s_waitcnt lgkmcnt(3)
    s_barrier
    v_mfma_f32_16x16x32_bf16 v[20:23], a[0:3], v[128:131], 0
    ds_read_b128 v[144:147], v105 offset:0
    v_mfma_f32_16x16x32_bf16 v[24:27], a[64:67], v[128:131], 0
    ds_read_b128 v[148:151], v105 offset:1024
    buffer_store_dword v33, v19, s[28:31], s8 offen
    s_waitcnt lgkmcnt(4)
    v_mfma_f32_16x16x32_bf16 v[20:23], a[4:7], v[132:135], v[20:23]
    ds_read_b128 v[152:155], v105 offset:2048
    v_mfma_f32_16x16x32_bf16 v[24:27], a[68:71], v[132:135], v[24:27]
    ds_read_b128 v[156:159], v105 offset:3072
    s_waitcnt lgkmcnt(5)
    v_mfma_f32_16x16x32_bf16 v[20:23], a[8:11], v[136:139], v[20:23]
    ds_read_b128 v[160:163], v106 offset:0
    v_mfma_f32_16x16x32_bf16 v[24:27], a[72:75], v[136:139], v[24:27]
    ds_read_b128 v[164:167], v106 offset:1024
    s_waitcnt lgkmcnt(6)
    v_mfma_f32_16x16x32_bf16 v[20:23], a[12:15], v[140:143], v[20:23]
    ds_read_b128 v[168:171], v106 offset:2048
    v_mfma_f32_16x16x32_bf16 v[24:27], a[76:79], v[140:143], v[24:27]
    buffer_load_dwordx4 v[208:211], v18, s[36:39], s62 offen nt
    s_add_u32 s62, s62, 32768
    s_waitcnt lgkmcnt(6)
    v_mfma_f32_16x16x32_bf16 v[20:23], a[16:19], v[144:147], v[20:23]
    ds_read_b128 v[172:175], v106 offset:3072
    v_mfma_f32_16x16x32_bf16 v[24:27], a[80:83], v[144:147], v[24:27]
    s_waitcnt lgkmcnt(6)
    v_mfma_f32_16x16x32_bf16 v[20:23], a[20:23], v[148:151], v[20:23]
    ds_read_b128 v[176:179], v107 offset:0
    v_mfma_f32_16x16x32_bf16 v[24:27], a[84:87], v[148:151], v[24:27]
    buffer_load_dwordx4 v[212:215], v18, s[36:39], s62 offen nt
    s_add_u32 s62, s62, 32768
    s_waitcnt lgkmcnt(6)
    v_mfma_f32_16x16x32_bf16 v[20:23], a[24:27], v[152:155], v[20:23]
    ds_read_b128 v[180:183], v107 offset:1024
    v_mfma_f32_16x16x32_bf16 v[24:27], a[88:91], v[152:155], v[24:27]
    s_waitcnt lgkmcnt(6)
    v_mfma_f32_16x16x32_bf16 v[20:23], a[28:31], v[156:159], v[20:23]
    ds_read_b128 v[184:187], v107 offset:2048
    v_mfma_f32_16x16x32_bf16 v[24:27], a[92:95], v[156:159], v[24:27]
    buffer_load_dwordx4 v[216:219], v18, s[36:39], s62 offen nt
    s_add_u32 s62, s62, 32768
    s_waitcnt lgkmcnt(6)
    v_mfma_f32_16x16x32_bf16 v[20:23], a[32:35], v[160:163], v[20:23]
    ds_read_b128 v[188:191], v107 offset:3072
    v_mfma_f32_16x16x32_bf16 v[24:27], a[96:99], v[160:163], v[24:27]
    s_waitcnt lgkmcnt(6)
    v_mfma_f32_16x16x32_bf16 v[20:23], a[36:39], v[164:167], v[20:23]
    v_mfma_f32_16x16x32_bf16 v[24:27], a[100:103], v[164:167], v[24:27]
    buffer_load_dwordx4 v[220:223], v18, s[36:39], s62 offen nt
    s_add_u32 s62, s62, 32768
    s_waitcnt lgkmcnt(5)
    v_mfma_f32_16x16x32_bf16 v[20:23], a[40:43], v[168:171], v[20:23]
    v_mfma_f32_16x16x32_bf16 v[24:27], a[104:107], v[168:171], v[24:27]
    s_waitcnt lgkmcnt(4)
    v_mfma_f32_16x16x32_bf16 v[20:23], a[44:47], v[172:175], v[20:23]
    v_mfma_f32_16x16x32_bf16 v[24:27], a[108:111], v[172:175], v[24:27]
    s_waitcnt lgkmcnt(3)
    v_mfma_f32_16x16x32_bf16 v[20:23], a[48:51], v[176:179], v[20:23]
    v_mfma_f32_16x16x32_bf16 v[24:27], a[112:115], v[176:179], v[24:27]
    s_waitcnt lgkmcnt(2)
    v_mfma_f32_16x16x32_bf16 v[20:23], a[52:55], v[180:183], v[20:23]
    v_mfma_f32_16x16x32_bf16 v[24:27], a[116:119], v[180:183], v[24:27]
    s_waitcnt lgkmcnt(1)
    v_mfma_f32_16x16x32_bf16 v[20:23], a[56:59], v[184:187], v[20:23]
    v_mfma_f32_16x16x32_bf16 v[24:27], a[120:123], v[184:187], v[24:27]
    s_waitcnt lgkmcnt(0)
    v_mfma_f32_16x16x32_bf16 v[20:23], a[60:63], v[188:191], v[20:23]
    v_mfma_f32_16x16x32_bf16 v[24:27], a[124:127], v[188:191], v[24:27]
    s_nop 2
    v_mov_b32 v250, v0
    s_nop 2
    v_max3_f32 v28, v20, v21, v22
    v_max3_f32 v29, v24, v25, v26
    v_max3_f32 v28, v28, v23, v27
    v_max_f32 v28, v28, v29
    ds_max_f32 v13, v28
    v_pk_add_f32 v[20:21], v[20:21], v[28:29] op_sel_hi:[1,0] neg_lo:[0,1] neg_hi:[0,1]
    v_pk_add_f32 v[22:23], v[22:23], v[28:29] op_sel_hi:[1,0] neg_lo:[0,1] neg_hi:[0,1]
    v_pk_add_f32 v[24:25], v[24:25], v[28:29] op_sel_hi:[1,0] neg_lo:[0,1] neg_hi:[0,1]
    v_pk_add_f32 v[26:27], v[26:27], v[28:29] op_sel_hi:[1,0] neg_lo:[0,1] neg_hi:[0,1]
    v_exp_f32 v20, v20
    v_exp_f32 v21, v21
    v_exp_f32 v22, v22
    v_exp_f32 v23, v23
    s_waitcnt lgkmcnt(0)
    s_barrier
    ds_read_b32 v32, v13
    v_exp_f32 v24, v24
    v_exp_f32 v25, v25
    v_exp_f32 v26, v26
    v_exp_f32 v27, v27
    v_pk_add_f32 v[36:37], v[20:21], v[22:23]
    v_pk_add_f32 v[38:39], v[24:25], v[26:27]
    v_pk_add_f32 v[36:37], v[36:37], v[38:39]
    s_waitcnt lgkmcnt(0)
    v_sub_f32 v38, v28, v32
    v_exp_f32 v38, v38
    v_add_f32 v36, v36, v37
    v_pk_mul_f32 v[20:21], v[20:21], v[38:39] op_sel_hi:[1,0]
    v_pk_mul_f32 v[22:23], v[22:23], v[38:39] op_sel_hi:[1,0]
    v_pk_mul_f32 v[24:25], v[24:25], v[38:39] op_sel_hi:[1,0]
    v_pk_mul_f32 v[26:27], v[26:27], v[38:39] op_sel_hi:[1,0]
    v_cvt_pk_bf16_f32 v28, v20, v21
    v_cvt_pk_bf16_f32 v29, v22, v23
    v_cvt_pk_bf16_f32 v30, v24, v25
    v_cvt_pk_bf16_f32 v31, v26, v27
    ds_write_b128 v14, v[28:31]
    v_mul_f32 v36, v36, v38
    ds_write_b32 v12, v36
    s_waitcnt lgkmcnt(0)
    s_barrier
    s_waitcnt vmcnt(5)
    ds_read_b128 v[64:67], v15 offset:0
    ds_read_b128 v[68:71], v15 offset:1024
    ds_read_b128 v[72:75], v15 offset:2048
    ds_read_b128 v[76:79], v15 offset:3072
    ds_read_b128 v[36:39], v15 offset:7168
    s_waitcnt lgkmcnt(4)
    v_mfma_f32_16x16x32_bf16 v[80:83], v[64:67], a[128:131], 0
    v_mfma_f32_16x16x32_bf16 v[84:87], v[64:67], a[144:147], 0
    s_waitcnt lgkmcnt(3)
    v_mfma_f32_16x16x32_bf16 v[80:83], v[68:71], a[132:135], v[80:83]
    v_mfma_f32_16x16x32_bf16 v[84:87], v[68:71], a[148:151], v[84:87]
    s_waitcnt lgkmcnt(2)
    v_mfma_f32_16x16x32_bf16 v[80:83], v[72:75], a[136:139], v[80:83]
    v_mfma_f32_16x16x32_bf16 v[84:87], v[72:75], a[152:155], v[84:87]
    s_waitcnt lgkmcnt(1)
    v_mfma_f32_16x16x32_bf16 v[80:83], v[76:79], a[140:143], v[80:83]
    s_waitcnt lgkmcnt(0)
    v_add_f32 v36, v36, v37
    v_mfma_f32_16x16x32_bf16 v[84:87], v[76:79], a[156:159], v[84:87]
    v_add_f32 v38, v38, v39
    v_mfma_f32_16x16x32_bf16 v[88:91], v[64:67], a[160:163], 0
    v_add_f32 v34, v36, v38
    v_add_f32 v36, v36, v38
    v_mfma_f32_16x16x32_bf16 v[92:95], v[64:67], a[176:179], 0
    v_mfma_f32_16x16x32_bf16 v[88:91], v[68:71], a[164:167], v[88:91]
    v_permlane32_swap_b32 v34, v36
    v_mfma_f32_16x16x32_bf16 v[92:95], v[68:71], a[180:183], v[92:95]
    v_add_f32 v34, v34, v36
    v_mov_b32 v36, v34
    v_mfma_f32_16x16x32_bf16 v[88:91], v[72:75], a[168:171], v[88:91]
    v_perm_b32 v112, v84, v80, s3
    v_bfi_b32 v112, s48, v48, v112
    v_mfma_f32_16x16x32_bf16 v[92:95], v[72:75], a[184:187], v[92:95]
    v_perm_b32 v116, v85, v81, s3
    v_bfi_b32 v116, s48, v48, v116
    v_mfma_f32_16x16x32_bf16 v[88:91], v[76:79], a[172:175], v[88:91]
    v_perm_b32 v120, v86, v82, s3
    v_bfi_b32 v120, s48, v48, v120
    v_mfma_f32_16x16x32_bf16 v[92:95], v[76:79], a[188:191], v[92:95]
    v_perm_b32 v124, v87, v83, s3
    v_bfi_b32 v124, s48, v48, v124
    v_mfma_f32_16x16x32_bf16 v[96:99], v[64:67], a[192:195], 0
    v_permlane16_swap_b32 v34, v36
    v_mfma_f32_16x16x32_bf16 v[100:103], v[64:67], a[208:211], 0
    v_add_f32 v34, v34, v36
    v_mfma_f32_16x16x32_bf16 v[96:99], v[68:71], a[196:199], v[96:99]
    buffer_store_dwordx4 v[32:35], v17, s[28:31], s61 offen sc1
    v_mfma_f32_16x16x32_bf16 v[100:103], v[68:71], a[212:215], v[100:103]
    v_mfma_f32_16x16x32_bf16 v[96:99], v[72:75], a[200:203], v[96:99]
    v_perm_b32 v113, v92, v88, s3
    v_bfi_b32 v113, s48, v49, v113
    v_mfma_f32_16x16x32_bf16 v[100:103], v[72:75], a[216:219], v[100:103]
    v_perm_b32 v117, v93, v89, s3
    v_bfi_b32 v117, s48, v49, v117
    v_mfma_f32_16x16x32_bf16 v[96:99], v[76:79], a[204:207], v[96:99]
    v_perm_b32 v121, v94, v90, s3
    v_bfi_b32 v121, s48, v49, v121
    v_mfma_f32_16x16x32_bf16 v[100:103], v[76:79], a[220:223], v[100:103]
    v_perm_b32 v125, v95, v91, s3
    v_bfi_b32 v125, s48, v49, v125
    v_mfma_f32_16x16x32_bf16 v[104:107], v[64:67], a[224:227], 0
    buffer_store_dwordx2 v[112:113], v16, s[28:31], s4 offen sc1
    v_mfma_f32_16x16x32_bf16 v[108:111], v[64:67], a[240:243], 0
    buffer_store_dwordx2 v[116:117], v16, s[28:31], s5 offen sc1
    v_mfma_f32_16x16x32_bf16 v[104:107], v[68:71], a[228:231], v[104:107]
    buffer_store_dwordx2 v[120:121], v16, s[28:31], s6 offen sc1
    v_mfma_f32_16x16x32_bf16 v[108:111], v[68:71], a[244:247], v[108:111]
    buffer_store_dwordx2 v[124:125], v16, s[28:31], s7 offen sc1
    v_mfma_f32_16x16x32_bf16 v[104:107], v[72:75], a[232:235], v[104:107]
    v_perm_b32 v114, v100, v96, s3
    v_bfi_b32 v114, s48, v50, v114
    v_mfma_f32_16x16x32_bf16 v[108:111], v[72:75], a[248:251], v[108:111]
    v_perm_b32 v118, v101, v97, s3
    v_bfi_b32 v118, s48, v50, v118
    v_mfma_f32_16x16x32_bf16 v[104:107], v[76:79], a[236:239], v[104:107]
    v_perm_b32 v122, v102, v98, s3
    v_bfi_b32 v122, s48, v50, v122
    v_mfma_f32_16x16x32_bf16 v[108:111], v[76:79], a[252:255], v[108:111]
    v_perm_b32 v126, v103, v99, s3
    v_bfi_b32 v126, s48, v50, v126
    s_nop 2
    v_mov_b32 v250, v0
    s_nop 1
    v_perm_b32 v115, v108, v104, s3
    v_bfi_b32 v115, s48, v51, v115
    buffer_store_dwordx2 v[114:115], v16, s[28:31], s4 offen offset:128 sc1
    v_perm_b32 v119, v109, v105, s3
    v_bfi_b32 v119, s48, v51, v119
    buffer_store_dwordx2 v[118:119], v16, s[28:31], s5 offen offset:128 sc1
    v_perm_b32 v123, v110, v106, s3
    v_bfi_b32 v123, s48, v51, v123
    buffer_store_dwordx2 v[122:123], v16, s[28:31], s6 offen offset:128 sc1
    v_perm_b32 v127, v111, v107, s3
    v_bfi_b32 v127, s48, v51, v127
    buffer_store_dwordx2 v[126:127], v16, s[28:31], s7 offen offset:128 sc1
    s_waitcnt vmcnt(9)
    ds_write_b128 v40, v[192:195] offset:0
    ds_write_b128 v40, v[196:199] offset:9728
    ds_write_b128 v40, v[200:203] offset:19456
    ds_write_b128 v40, v[204:207] offset:29184
    ds_write_b128 v40, v[208:211] offset:288
    ds_write_b128 v40, v[212:215] offset:10016
    ds_write_b128 v40, v[216:219] offset:19744
    ds_write_b128 v40, v[220:223] offset:29472
    s_waitcnt lgkmcnt(0)
    s_barrier
    ds_read_b64_tr_b16 a[0:1], v41 offset:0
    ds_read_b64_tr_b16 a[2:3], v41 offset:2432
    ds_read_b64_tr_b16 a[4:5], v41 offset:19456
    ds_read_b64_tr_b16 a[6:7], v41 offset:21888
    ds_read_b64_tr_b16 a[8:9], v41 offset:1152
    ds_read_b64_tr_b16 a[10:11], v41 offset:3584
    ds_read_b64_tr_b16 a[12:13], v41 offset:20608
    ds_read_b64_tr_b16 a[14:15], v41 offset:23040
    ds_read_b64_tr_b16 a[16:17], v41 offset:32
    ds_read_b64_tr_b16 a[18:19], v41 offset:2464
    ds_read_b64_tr_b16 a[20:21], v41 offset:19488
    ds_read_b64_tr_b16 a[22:23], v41 offset:21920
    ds_read_b64_tr_b16 a[24:25], v41 offset:1184
    ds_read_b64_tr_b16 a[26:27], v41 offset:3616
    ds_read_b64_tr_b16 a[28:29], v41 offset:20640
    ds_read_b64_tr_b16 a[30:31], v41 offset:23072
    buffer_load_dwordx4 v[28:31], v3, s[28:31], s9 offen sc1
    s_mov_b32 s50, 0
    s_waitcnt vmcnt(0)
    s_branch L_pollS2
L_pollS:
    s_add_u32 s50, s50, 1
    s_cmp_gt_u32 s50, 40000
    s_cbranch_scc1 L_fail
    buffer_load_dwordx4 v[28:31], v3, s[28:31], s9 offen sc1
    s_waitcnt vmcnt(0)
L_pollS2:
    v_bitop3_b32 v44, v29, v31, s44 bitop3:0x7e
    v_cmp_ne_u32 vcc, 0, v44
    v_mov_b32 v32, v28
    s_cbranch_vccnz L_pollS
    s_barrier
    buffer_load_dwordx4 v[64:67], v3, s[28:31], s10 offen offset:0 sc1
    buffer_load_dwordx4 v[68:71], v3, s[28:31], s10 offen offset:1024 sc1
    buffer_load_dwordx4 v[72:75], v3, s[28:31], s11 offen offset:0 sc1
    buffer_load_dwordx4 v[76:79], v3, s[28:31], s11 offen offset:1024 sc1
    v_max_f32_dpp v32, v32, v32 quad_perm:[1,0,3,2] row_mask:0xf bank_mask:0xf
    s_nop 1
    v_max_f32_dpp v32, v32, v32 quad_perm:[2,3,0,1] row_mask:0xf bank_mask:0xf
    s_nop 1
    v_max_f32_dpp v32, v32, v32 row_half_mirror row_mask:0xf bank_mask:0xf
    s_nop 1
    v_max_f32_dpp v32, v32, v32 row_mirror row_mask:0xf bank_mask:0xf
    v_mov_b32 v33, v32
    s_nop 1
    v_permlane16_swap_b32 v32, v33
    v_max_f32 v32, v32, v33
    v_sub_f32 v28, v28, v32
    v_exp_f32 v28, v28
    s_nop 0
    v_mul_f32 v30, v28, v30
    s_nop 1
    v_add_f32_dpp v30, v30, v30 quad_perm:[1,0,3,2] row_mask:0xf bank_mask:0xf
    s_nop 1
    v_add_f32_dpp v30, v30, v30 quad_perm:[2,3,0,1] row_mask:0xf bank_mask:0xf
    s_nop 1
    v_add_f32_dpp v30, v30, v30 row_half_mirror row_mask:0xf bank_mask:0xf
    s_nop 1
    v_add_f32_dpp v30, v30, v30 row_mirror row_mask:0xf bank_mask:0xf
    v_mov_b32 v33, v30
    s_nop 1
    v_permlane16_swap_b32 v30, v33
    v_add_f32 v30, v30, v33
    v_rcp_f32 v30, v30
    s_nop 0
    v_mul_f32 v28, v28, v30
    v_cvt_pk_bf16_f32 v28, v28, v28
    ds_bpermute_b32 v32, v43, v28
    ds_bpermute_b32 v33, v43, v28 offset:16
    s_waitcnt lgkmcnt(0)
    v_and_b32 v80, v32, v224
    v_and_b32 v81, v32, v225
    v_and_b32 v82, v32, v226
    v_and_b32 v83, v32, v227
    v_and_b32 v84, v33, v224
    v_and_b32 v85, v33, v225
    v_and_b32 v86, v33, v226
    v_and_b32 v87, v33, v227
    v_and_b32 v88, v32, v228
    v_and_b32 v89, v32, v229
    v_and_b32 v90, v32, v230
    v_and_b32 v91, v32, v231
    v_and_b32 v92, v33, v228
    v_and_b32 v93, v33, v229
    v_and_b32 v94, v33, v230
    v_and_b32 v95, v33, v231
    s_mov_b32 s50, 0
    s_branch L_pollD_chk
L_pollD:
    buffer_load_dwordx4 v[64:67], v3, s[28:31], s10 offen offset:0 sc1
    buffer_load_dwordx4 v[68:71], v3, s[28:31], s10 offen offset:1024 sc1
    buffer_load_dwordx4 v[72:75], v3, s[28:31], s11 offen offset:0 sc1
    buffer_load_dwordx4 v[76:79], v3, s[28:31], s11 offen offset:1024 sc1
    s_add_u32 s50, s50, 1
    s_cmp_gt_u32 s50, 40000
    s_cbranch_scc1 L_fail
L_pollD_chk:
    s_waitcnt vmcnt(3)
    v_xor_b32 v64, v64, v60
    v_xor_b32 v65, v65, v61
    v_xor_b32 v66, v66, v62
    v_xor_b32 v67, v67, v63
    v_bitop3_b32 v44, v64, v65, s48 bitop3:0x80
    v_bitop3_b32 v44, v44, v66, v67 bitop3:0x80
    v_mfma_f32_16x16x32_bf16 v[96:99], v[80:83], v[64:67], 0
    s_waitcnt vmcnt(2)
    v_xor_b32 v68, v68, v60
    v_xor_b32 v69, v69, v61
    v_xor_b32 v70, v70, v62
    v_xor_b32 v71, v71, v63
    v_bitop3_b32 v44, v68, v69, v44 bitop3:0x80
    v_bitop3_b32 v44, v44, v70, v71 bitop3:0x80
    v_mfma_f32_16x16x32_bf16 v[96:99], v[84:87], v[68:71], v[96:99]
    s_waitcnt vmcnt(1)
    v_xor_b32 v72, v72, v60
    v_xor_b32 v73, v73, v61
    v_xor_b32 v74, v74, v62
    v_xor_b32 v75, v75, v63
    v_bitop3_b32 v44, v72, v73, v44 bitop3:0x80
    v_bitop3_b32 v44, v44, v74, v75 bitop3:0x80
    v_mfma_f32_16x16x32_bf16 v[96:99], v[88:91], v[72:75], v[96:99]
    s_waitcnt vmcnt(0)
    v_xor_b32 v76, v76, v60
    v_xor_b32 v77, v77, v61
    v_xor_b32 v78, v78, v62
    v_xor_b32 v79, v79, v63
    v_bitop3_b32 v44, v76, v77, v44 bitop3:0x80
    v_bitop3_b32 v44, v44, v78, v79 bitop3:0x80
    v_mfma_f32_16x16x32_bf16 v[96:99], v[92:95], v[76:79], v[96:99]
    v_cmp_ne_u32 vcc, s48, v44
    s_cbranch_vccnz L_pollD
L_pollD_ok:
    s_nop 2
    v_mov_b32 v250, v0
    s_nop 1
    v_cvt_pk_bf16_f32 v96, v96, v97
    v_cvt_pk_bf16_f32 v97, v98, v99
    ds_write_b64 v46, v[96:97]
    s_waitcnt lgkmcnt(0)
    s_barrier
    ds_read_b128 v[64:67], v47 offset:0
    ds_read_b128 v[68:71], v47 offset:64
    ds_read_b128 v[72:75], v47 offset:128
    ds_read_b128 v[76:79], v47 offset:192
    s_waitcnt lgkmcnt(3)
    v_mfma_f32_16x16x32_bf16 v[96:99], v[64:67], a[0:3], 0
    v_mfma_f32_16x16x32_bf16 v[100:103], v[64:67], a[16:19], 0
    s_waitcnt lgkmcnt(2)
    v_mfma_f32_16x16x32_bf16 v[96:99], v[68:71], a[4:7], v[96:99]
    v_mfma_f32_16x16x32_bf16 v[100:103], v[68:71], a[20:23], v[100:103]
    s_waitcnt lgkmcnt(1)
    v_mfma_f32_16x16x32_bf16 v[96:99], v[72:75], a[8:11], v[96:99]
    v_mfma_f32_16x16x32_bf16 v[100:103], v[72:75], a[24:27], v[100:103]
    s_waitcnt lgkmcnt(0)
    v_mfma_f32_16x16x32_bf16 v[96:99], v[76:79], a[12:15], v[96:99]
    v_mfma_f32_16x16x32_bf16 v[100:103], v[76:79], a[28:31], v[100:103]
    s_nop 2
    v_mov_b32 v250, v0
    s_nop 2
    v_pk_add_f32 v[96:97], v[96:97], v[98:99]
    v_pk_add_f32 v[100:101], v[100:101], v[102:103]
    s_nop 1
    v_permlane16_swap_b32 v96, v100
    v_permlane16_swap_b32 v97, v101
    v_pk_add_f32 v[96:97], v[96:97], v[100:101]
    v_perm_b32 v96, v97, v96, s3
    v_bfi_b32 v96, s48, v52, v96
    buffer_store_dword v96, v42, s[28:31], s15 offen
    s_waitcnt vmcnt(0)
    s_barrier
    buffer_store_dword v96, v42, s[28:31], s14 offen sc1
    s_lshl_b32 s61, s45, 3
    s_add_u32 s61, s61, s46
    s_cmp_ge_u32 s61, 27
    s_cbranch_scc1 L_done
    s_cmp_ge_u32 s47, 10
    s_cbranch_scc1 L_done
    s_load_dwordx2 s[32:33], s[0:1], 64
    s_mov_b32 s34, 2211840
    v_lshrrev_b32 v4, 3, v0
    v_and_b32 v5, 2, v4
    v_and_b32 v6, 7, v0
    v_xor_b32 v5, v5, v6
    v_lshlrev_b32 v5, 4, v5
    s_movk_i32 s54, 1280
    v_mad_u32_u24 v4, v4, s54, v5
    v_and_b32 v5, 1, v1
    v_bfe_u32 v6, v1, 1, 1
    v_lshl_add_u32 v5, v5, 1, v6
    v_lshlrev_b32 v7, 6, v2
    v_lshl_add_u32 v7, v5, 4, v7
    s_lshl_b32 s57, s61, 8
    s_add_u32 s57, s57, 720896
    buffer_load_dwordx4 v[64:67], v7, s[28:31], s57 offen sc1
    s_mul_i32 s54, s61, 81920
    s_lshl_b32 s55, s47, 7
    s_add_u32 s54, s54, s55
    s_mul_i32 s55, s45, 8448
    s_add_u32 s55, s55, 40960
    s_mov_b32 m0, s55
    s_waitcnt lgkmcnt(0)
    buffer_load_dwordx4 v4, s[32:35], s54 offen nt lds
    s_add_u32 m0, m0, 1056
    s_add_u32 s54, s54, 10240
    buffer_load_dwordx4 v4, s[32:35], s54 offen nt lds
    s_add_u32 m0, m0, 1056
    s_add_u32 s54, s54, 10240
    buffer_load_dwordx4 v4, s[32:35], s54 offen nt lds
    s_add_u32 m0, m0, 1056
    s_add_u32 s54, s54, 10240
    buffer_load_dwordx4 v4, s[32:35], s54 offen nt lds
    s_add_u32 m0, m0, 1056
    s_add_u32 s54, s54, 10240
    buffer_load_dwordx4 v4, s[32:35], s54 offen nt lds
    s_add_u32 m0, m0, 1056
    s_add_u32 s54, s54, 10240
    buffer_load_dwordx4 v4, s[32:35], s54 offen nt lds
    s_add_u32 m0, m0, 1056
    s_add_u32 s54, s54, 10240
    buffer_load_dwordx4 v4, s[32:35], s54 offen nt lds
    s_add_u32 m0, m0, 1056
    s_add_u32 s54, s54, 10240
    buffer_load_dwordx4 v4, s[32:35], s54 offen nt lds
    v_lshlrev_b32 v44, 2, v5
    v_lshrrev_b32_e64 v56, v44, s44
    v_lshrrev_b32 v57, 1, v56
    v_lshrrev_b32 v58, 2, v56
    v_lshrrev_b32 v59, 3, v56
    v_bitop3_b32 v56, v56, v56, s48 bitop3:0x0a
    v_bitop3_b32 v57, v57, v57, s48 bitop3:0x0a
    v_bitop3_b32 v58, v58, v58, s48 bitop3:0x0a
    v_bitop3_b32 v59, v59, v59, s48 bitop3:0x0a
    v_lshrrev_b32 v5, 1, v10
    v_lshlrev_b32 v5, 5, v5
    v_lshl_add_u32 v5, v10, 7, v5
    v_lshl_add_u32 v5, v9, 3, v5
    v_xor_b32 v6, 32, v5
    v_mul_u32_u24 v8, 2112, v2
    v_add3_u32 v5, v5, v8, s55
    v_add3_u32 v6, v6, v8, s55
    v_lshrrev_b32 v14, 1, v2
    v_lshlrev_b32 v14, 12, v14
    v_and_b32 v15, 31, v0
    v_lshl_add_u32 v14, v15, 2, v14
    s_lshl_b32 s58, s47, 13
    s_lshl_b32 s59, s61, 7
    s_add_u32 s58, s58, s59
    s_add_u32 s58, s58, 425984
    s_add_u32 s8, s8, 0x3000
    s_mov_b32 s4, 0xffff0000
    s_mov_b32 s5, 0xffff0000
    s_mov_b32 s6, 0
    s_mov_b32 s7, -1
    buffer_load_dword v68, v14, s[28:31], s58 offen sc1
    s_waitcnt vmcnt(0)
    ds_read_b64_tr_b16 a[0:1], v5 offset:0
    ds_read_b64_tr_b16 a[2:3], v5 offset:512
    ds_read_b64_tr_b16 a[4:5], v5 offset:1056
    ds_read_b64_tr_b16 a[6:7], v5 offset:1568
    ds_read_b64_tr_b16 a[8:9], v6 offset:0
    ds_read_b64_tr_b16 a[10:11], v6 offset:512
    ds_read_b64_tr_b16 a[12:13], v6 offset:1056
    ds_read_b64_tr_b16 a[14:15], v6 offset:1568
    ds_read_b64_tr_b16 a[16:17], v5 offset:64
    ds_read_b64_tr_b16 a[18:19], v5 offset:576
    ds_read_b64_tr_b16 a[20:21], v5 offset:1120
    ds_read_b64_tr_b16 a[22:23], v5 offset:1632
    ds_read_b64_tr_b16 a[24:25], v6 offset:64
    ds_read_b64_tr_b16 a[26:27], v6 offset:576
    ds_read_b64_tr_b16 a[28:29], v6 offset:1120
    ds_read_b64_tr_b16 a[30:31], v6 offset:1632
    s_waitcnt lgkmcnt(0)
    s_mov_b32 s50, 0
L_pollG:
    s_cmp_gt_u32 s50, 256
    s_cselect_b32 s49, 524288, 0
    s_xor_b32 s57, s57, s49
    buffer_load_dwordx4 v[64:67], v7, s[28:31], s57 offen offset:0 sc1
    s_add_u32 s50, s50, 1
    s_cmp_gt_u32 s50, 40000
    s_cbranch_scc1 L_fail
L_pollG_chk:
    s_waitcnt vmcnt(0)
    v_xor_b32 v64, v64, v56
    v_xor_b32 v65, v65, v57
    v_xor_b32 v66, v66, v58
    v_xor_b32 v67, v67, v59
    v_bitop3_b32 v44, v64, v65, s48 bitop3:0x80
    v_bitop3_b32 v44, v44, v66, v67 bitop3:0x80
    v_mov_b32_dpp v68, v64 quad_perm:[2,3,0,1] row_mask:0xf bank_mask:0xf
    v_mov_b32_dpp v69, v65 quad_perm:[2,3,0,1] row_mask:0xf bank_mask:0xf
    v_mov_b32_dpp v70, v66 quad_perm:[2,3,0,1] row_mask:0xf bank_mask:0xf
    v_mov_b32_dpp v71, v67 quad_perm:[2,3,0,1] row_mask:0xf bank_mask:0xf
    v_cmp_ne_u32 vcc, s48, v44
    s_cbranch_vccnz L_pollG
L_pollG_ok:
    v_mfma_f32_16x16x32_bf16 v[80:83], v[64:67], a[0:3], 0
    v_mfma_f32_16x16x32_bf16 v[80:83], v[68:71], a[4:7], v[80:83]
    v_mfma_f32_16x16x32_bf16 v[84:87], v[64:67], a[8:11], 0
    v_mfma_f32_16x16x32_bf16 v[84:87], v[68:71], a[12:15], v[84:87]
    v_mfma_f32_16x16x32_bf16 v[88:91], v[64:67], a[16:19], 0
    v_mfma_f32_16x16x32_bf16 v[88:91], v[68:71], a[20:23], v[88:91]
    v_mfma_f32_16x16x32_bf16 v[92:95], v[64:67], a[24:27], 0
    v_mfma_f32_16x16x32_bf16 v[92:95], v[68:71], a[28:31], v[92:95]
    s_barrier
    s_nop 0
    v_perm_b32 v80, v81, v80, s3
    s_nop 0
    v_perm_b32 v84, v85, v84, s3
    v_cndmask_b32_e64 v80, v80, v84, s[4:5]
    v_perm_b32 v88, v89, v88, s3
    s_nop 0
    v_perm_b32 v92, v93, v92, s3
    v_cndmask_b32_e64 v88, v88, v92, s[4:5]
    v_cndmask_b32_e64 v80, v80, v88, s[6:7]
    v_bfi_b32 v80, s48, v52, v80
    buffer_store_dword v35, v19, s[28:31], s8 offen
    buffer_store_dword v80, v14, s[28:31], s58 offen sc1
L_done:
L_fail:
L_end:
    s_endpgm
.section .rodata,"a"
.p2align 6
.amdhsa_kernel sequential_preLN__compressed_kv_cla__dense_activation_silu__decode_kernel
  .amdhsa_next_free_vgpr 512
  .amdhsa_next_free_sgpr 102
  .amdhsa_accum_offset 256
  .amdhsa_group_segment_fixed_size 0
  .amdhsa_kernarg_size 96
  .amdhsa_user_sgpr_count 2
  .amdhsa_user_sgpr_kernarg_segment_ptr 1
  .amdhsa_system_sgpr_workgroup_id_x 1
.end_amdhsa_kernel
```
